```python
import torch

def _softmax(x, axis=-1):
    return torch.softmax(x, dim=axis)
def _gelu(x):
    return torch.nn.functional.gelu(x, approximate="tanh")
def _silu(x):
    return torch.nn.functional.silu(x)
def _sigmoid(x):
    return torch.sigmoid(x)
def _layernorm(x, axis=-1, eps=1e-5):
    m = x.mean(dim=axis, keepdim=True)
    v = x.var(dim=axis, keepdim=True, unbiased=False)
    return (x - m) / torch.sqrt(v + eps)
def _scatter_add(tgt, idx, src, axis=0):
    return tgt.clone().index_add_(axis, idx, src)
def _segment_sum(src, seg, n):
    out = torch.zeros((n,) + src.shape[1:], dtype=src.dtype)
    return out.index_add_(0, seg, src)
def _pad(x, pw):
    flat = tuple(v for pair in reversed(pw) for v in pair)
    return torch.nn.functional.pad(x, flat)

kernel_name = 'gather_scatter__mpnn_edge_mlp__graph'

def setup_inputs():

    _w = (lambda a: (lambda t: t.to(torch.bfloat16) if t.is_floating_point() else t)(torch.as_tensor(a)))
    N, deg, D, De = 10000, 16, 128, max(4, 1)
    E = N * deg
    return {
        "x": _w((lambda *s: torch.randn(*s, dtype=torch.bfloat16) * 0.05)(N, D)),
        "e_attr": _w((lambda *s: torch.randn(*s, dtype=torch.bfloat16) * 0.4)(E, De)),
        "src": _w((lambda lo, hi, *s: torch.randint(lo, hi, s))(0, N, E).to(torch.int64)),
        "dst": _w((lambda lo, hi, *s: torch.randint(lo, hi, s))(0, N, E).to(torch.int64)),
        "w_msg": _w((lambda *s: torch.randn(*s, dtype=torch.bfloat16) * 0.4)(2 * D + De, D)),
        "w_upd": _w((lambda *s: torch.randn(*s, dtype=torch.bfloat16) * 0.05)(2 * D, D)),
    }

def reference(x, e_attr, src, dst, w_msg, w_upd):
    N, D = x.shape
    m_in = torch.concatenate([x[src], x[dst], e_attr], axis=-1)
    msg = _silu(m_in @ w_msg)
    agg = _segment_sum(msg, dst, N)
    return _silu(torch.concatenate([x, agg], axis=-1) @ w_upd)
```

```asm
; @launch kernel=mpnn_prep_kernel grid=(256,1,1) block=(640,1,1) lds=114688
; @launch kernel=gather_scatter__mpnn_edge_mlp__graph_kernel grid=(512,1,1) block=(256,1,1) lds=65552
.amdgcn_target "amdgcn-amd-amdhsa--gfx950"
.text
.globl mpnn_prep_kernel
.p2align 8
.type mpnn_prep_kernel,@function
mpnn_prep_kernel:
    s_cmp_ge_u32 s2, 256
    s_cbranch_scc1 K1_END
    s_load_dwordx16 s[8:23], s[0:1], 0
    s_load_dwordx2 s[24:25], s[0:1], 64
    s_cmp_lt_u32 s2, 64
    s_cbranch_scc1 K1_SORT
    v_lshrrev_b32 v2, 6, v0
    v_and_b32 v1, 63, v0
    s_lshr_b32 s44, s2, 6
    v_readfirstlane_b32 s27, v2
    s_and_b32 s3, s2, 63
    v_lshrrev_b32 v5, 4, v0
    v_and_b32 v3, 15, v1
    v_and_b32 v6, 15, v5
    v_xor_b32 v6, v3, v6
    v_lshlrev_b32 v6, 4, v6
    v_lshl_or_b32 v6, v5, 8, v6
    s_mul_i32 s5, s3, 40960
    s_lshl_b32 s52, s44, 14
    s_add_u32 s57, s5, 40960
    s_add_u32 s52, s52, s5
    s_sub_u32 s52, s52, 16384
    s_mov_b32 s30, 2560000
    s_mov_b32 s31, 0x00020000
    s_lshl_b32 s7, s27, 10
    v_lshrrev_b32 v2, 4, v1
    v_lshlrev_b32 v4, 2, v2
    v_xor_b32 v4, v3, v4
    v_lshlrev_b32 v4, 4, v4
    v_lshl_or_b32 v4, v2, 8, v4
    s_lshl_b32 s6, s27, 12
    s_cmp_eq_u32 s44, 2
    s_cselect_b32 s49, 0x8000, 0
    s_mov_b32 s47, 3
    s_movk_i32 s48, 1024
    s_cmp_lg_u32 s3, 63
    s_cbranch_scc1 K1_G1
    s_cmp_lg_u32 s44, 3
    s_cbranch_scc1 K1_END
    s_mov_b32 s47, 2
    s_movk_i32 s48, 0x800
    s_mov_b32 s49, 0x8000
K1_G1:
    s_cmp_ge_u32 s27, 8
    s_cbranch_scc1 K1_NOLD
    s_add_u32 s49, s49, s6
    s_mov_b32 s38, 65536
    s_mov_b32 s39, 0x00020000
    s_add_u32 s53, s52, 8192
    s_cmp_eq_u32 s53, s57
    s_cselect_b32 s53, s5, s53
    s_lshl_b32 s60, s3, 7
    s_and_b32 s60, s60, 0xc00
    s_add_u32 m0, s6, s60
    s_add_u32 s4, s49, s60
    s_cmp_eq_u32 s44, 3
    s_waitcnt lgkmcnt(0)
    s_cselect_b32 s36, s18, s16
    s_cselect_b32 s37, s19, s17
    buffer_load_dwordx4 v4, s[36:39], s4 offen lds
    s_mov_b32 s28, s8
    s_mov_b32 s29, s9
    s_add_u32 m0, s7, 32768
    s_add_u32 s60, s60, 1024
    buffer_load_dwordx4 v6, s[28:31], s52 offen lds
    s_add_u32 m0, s7, 40960
    s_and_b32 s60, s60, 0xc00
    buffer_load_dwordx4 v6, s[28:31], s53 offen lds
    s_add_u32 m0, s6, s60
    s_add_u32 s4, s49, s60
    buffer_load_dwordx4 v4, s[36:39], s4 offen lds
    s_add_u32 s60, s60, 1024
    s_and_b32 s60, s60, 0xc00
    s_add_u32 m0, s6, s60
    s_add_u32 s4, s49, s60
    buffer_load_dwordx4 v4, s[36:39], s4 offen lds
    s_add_u32 s60, s60, 1024
    s_and_b32 s60, s60, 0xc00
    s_add_u32 m0, s6, s60
    s_add_u32 s4, s49, s60
    buffer_load_dwordx4 v4, s[36:39], s4 offen lds
    s_add_u32 m0, s7, 49152
    s_add_u32 s54, s53, 8192
    s_cmp_eq_u32 s54, s57
    s_cselect_b32 s54, s5, s54
    buffer_load_dwordx4 v6, s[28:31], s54 offen lds
    s_add_u32 m0, s7, 57344
    s_add_u32 s55, s54, 8192
    s_cmp_eq_u32 s55, s57
    s_cselect_b32 s55, s5, s55
    buffer_load_dwordx4 v6, s[28:31], s55 offen lds
    s_add_u32 m0, s7, 65536
    s_add_u32 s56, s55, 8192
    s_cmp_eq_u32 s56, s57
    s_cselect_b32 s56, s5, s56
    buffer_load_dwordx4 v6, s[28:31], s56 offen lds
K1_NOLD:
    s_waitcnt lgkmcnt(0)
    s_mul_i32 s6, s44, 2621440
    s_add_u32 s6, s6, 4292349952
    s_mov_b32 s34, 10027008
    s_mov_b32 s35, 0x00020000
    s_cmp_eq_u32 s44, 3
    s_cselect_b32 s6, 0, s6
    s_cselect_b32 s32, s20, s24
    s_cselect_b32 s33, s21, s25
    s_cselect_b32 s34, 2560000, s34
    s_cmp_lg_u32 s27, 8
    s_cbranch_scc1 K1_NOTW
    v_lshlrev_b32 v8, 12, v1
    s_add_u32 s4, s5, s6
    s_mov_b64 exec, 0x7ff
    buffer_load_dword v8, v8, s[32:35], s4 offen
    s_mov_b64 exec, -1
    s_waitcnt vmcnt(0)
K1_NOTW:
    s_and_b32 s26, s27, 1
    s_lshr_b32 s45, s27, 1
    s_lshl_b32 s4, s45, 13
    s_add_u32 s52, s52, s4
    s_cmp_ge_u32 s52, s57
    s_cselect_b32 s53, 40960, 0
    s_sub_u32 s52, s52, s53
    s_add_u32 s52, s52, s6
    s_lshl_b32 s6, s26, 7
    s_add_u32 s52, s52, s6
    s_add_u32 s53, s52, 4096
    v_and_b32 v8, 1, v1
    v_lshlrev_b32 v8, 4, v8
    v_bfe_u32 v9, v1, 1, 1
    v_lshl_or_b32 v8, v9, 2, v8
    v_bfe_u32 v9, v1, 4, 1
    v_lshl_or_b32 v8, v9, 3, v8
    v_bfe_u32 v10, v1, 2, 2
    v_lshrrev_b32 v11, 5, v1
    v_lshlrev_b32 v12, s47, v11
    v_add_u32 v12, v12, v10
    v_lshrrev_b32 v9, 3, v8
    s_lshl_b32 s6, s26, 3
    v_add_u32 v9, s6, v9
    v_lshlrev_b32 v10, 2, v10
    v_xor_b32 v9, v9, v10
    v_lshlrev_b32 v9, 4, v9
    v_lshl_or_b32 v9, v12, 8, v9
    v_and_b32 v8, 4, v8
    v_lshl_or_b32 v8, v8, 1, v9
    v_add_u32 v9, s48, v8
    v_xor_b32 v4, 64, v8
    v_xor_b32 v5, 64, v9
    v_and_b32 v12, 31, v1
    v_xor_b32 v13, v11, v3
    v_lshlrev_b32 v13, 4, v13
    v_lshl_or_b32 v13, v12, 8, v13
    s_add_u32 s4, s4, 32768
    v_add_u32 v13, s4, v13
    v_xor_b32 v24, 0, v13
    v_xor_b32 v25, 32, v13
    v_xor_b32 v26, 64, v13
    v_xor_b32 v27, 96, v13
    v_xor_b32 v28, 128, v13
    v_xor_b32 v29, 160, v13
    v_xor_b32 v30, 192, v13
    v_xor_b32 v31, 224, v13
    s_lshl_b32 s4, s27, 12
    s_add_u32 s4, s4, 73728
    v_and_b32 v3, 7, v1
    v_lshlrev_b32 v14, 1, v11
    v_xor_b32 v14, v14, v3
    v_lshlrev_b32 v14, 4, v14
    v_lshl_or_b32 v14, v12, 7, v14
    v_add_u32 v14, s4, v14
    v_xor_b32 v15, 16, v14
    v_xor_b32 v6, 64, v14
    v_xor_b32 v7, 0x50, v14
    v_lshrrev_b32 v10, 3, v1
    v_xor_b32 v2, v3, v10
    v_lshlrev_b32 v2, 4, v2
    v_lshl_or_b32 v2, v10, 7, v2
    v_add_u32 v2, s4, v2
    v_lshlrev_b32 v3, 4, v3
    v_lshl_or_b32 v3, v10, 8, v3
    s_mov_b32 s6, 0xbfb8aa3b
    s_mov_b32 s7, s6
    s_waitcnt vmcnt(0)
    s_barrier
    ds_read_b128 v[96:99], v24
    ds_read_b64_tr_b16 v[32:33], v8 offset:0
    ds_read_b64_tr_b16 v[34:35], v9 offset:0
    ds_read_b64_tr_b16 v[64:65], v4 offset:0
    ds_read_b64_tr_b16 v[66:67], v5 offset:0
    ds_read_b128 v[100:103], v25
    ds_read_b64_tr_b16 v[36:37], v8 offset:4096
    ds_read_b64_tr_b16 v[38:39], v9 offset:4096
    ds_read_b64_tr_b16 v[68:69], v4 offset:4096
    ds_read_b64_tr_b16 v[70:71], v5 offset:4096
    ds_read_b128 v[104:107], v26
    ds_read_b64_tr_b16 v[40:41], v8 offset:8192
    ds_read_b64_tr_b16 v[42:43], v9 offset:8192
    ds_read_b64_tr_b16 v[72:73], v4 offset:8192
    ds_read_b64_tr_b16 v[74:75], v5 offset:8192
    s_waitcnt lgkmcnt(12)
    v_mfma_f32_32x32x16_bf16 v[128:143], v[32:35], v[96:99], 0
    s_waitcnt lgkmcnt(10)
    v_mfma_f32_32x32x16_bf16 v[144:159], v[64:67], v[96:99], 0
    ds_read_b128 v[108:111], v27
    ds_read_b64_tr_b16 v[44:45], v8 offset:12288
    ds_read_b64_tr_b16 v[46:47], v9 offset:12288
    ds_read_b64_tr_b16 v[76:77], v4 offset:12288
    ds_read_b64_tr_b16 v[78:79], v5 offset:12288
    s_waitcnt lgkmcnt(12)
    v_mfma_f32_32x32x16_bf16 v[128:143], v[36:39], v[100:103], v[128:143]
    s_waitcnt lgkmcnt(10)
    v_mfma_f32_32x32x16_bf16 v[144:159], v[68:71], v[100:103], v[144:159]
    ds_read_b128 v[112:115], v28
    ds_read_b64_tr_b16 v[48:49], v8 offset:16384
    ds_read_b64_tr_b16 v[50:51], v9 offset:16384
    ds_read_b64_tr_b16 v[80:81], v4 offset:16384
    ds_read_b64_tr_b16 v[82:83], v5 offset:16384
    s_waitcnt lgkmcnt(12)
    v_mfma_f32_32x32x16_bf16 v[128:143], v[40:43], v[104:107], v[128:143]
    s_waitcnt lgkmcnt(10)
    v_mfma_f32_32x32x16_bf16 v[144:159], v[72:75], v[104:107], v[144:159]
    ds_read_b128 v[116:119], v29
    ds_read_b64_tr_b16 v[52:53], v8 offset:20480
    ds_read_b64_tr_b16 v[54:55], v9 offset:20480
    ds_read_b64_tr_b16 v[84:85], v4 offset:20480
    ds_read_b64_tr_b16 v[86:87], v5 offset:20480
    s_waitcnt lgkmcnt(12)
    v_mfma_f32_32x32x16_bf16 v[128:143], v[44:47], v[108:111], v[128:143]
    s_waitcnt lgkmcnt(10)
    v_mfma_f32_32x32x16_bf16 v[144:159], v[76:79], v[108:111], v[144:159]
    ds_read_b128 v[120:123], v30
    ds_read_b64_tr_b16 v[56:57], v8 offset:24576
    ds_read_b64_tr_b16 v[58:59], v9 offset:24576
    ds_read_b64_tr_b16 v[88:89], v4 offset:24576
    ds_read_b64_tr_b16 v[90:91], v5 offset:24576
    s_waitcnt lgkmcnt(12)
    v_mfma_f32_32x32x16_bf16 v[128:143], v[48:51], v[112:115], v[128:143]
    s_waitcnt lgkmcnt(10)
    v_mfma_f32_32x32x16_bf16 v[144:159], v[80:83], v[112:115], v[144:159]
    ds_read_b128 v[124:127], v31
    ds_read_b64_tr_b16 v[60:61], v8 offset:28672
    ds_read_b64_tr_b16 v[62:63], v9 offset:28672
    ds_read_b64_tr_b16 v[92:93], v4 offset:28672
    ds_read_b64_tr_b16 v[94:95], v5 offset:28672
    s_waitcnt lgkmcnt(12)
    v_mfma_f32_32x32x16_bf16 v[128:143], v[52:55], v[116:119], v[128:143]
    s_waitcnt lgkmcnt(10)
    v_mfma_f32_32x32x16_bf16 v[144:159], v[84:87], v[116:119], v[144:159]
    s_waitcnt lgkmcnt(7)
    v_mfma_f32_32x32x16_bf16 v[128:143], v[56:59], v[120:123], v[128:143]
    s_waitcnt lgkmcnt(5)
    v_mfma_f32_32x32x16_bf16 v[144:159], v[88:91], v[120:123], v[144:159]
    s_waitcnt lgkmcnt(2)
    v_mfma_f32_32x32x16_bf16 v[128:143], v[60:63], v[124:127], v[128:143]
    s_waitcnt lgkmcnt(0)
    v_mfma_f32_32x32x16_bf16 v[144:159], v[92:95], v[124:127], v[144:159]
    s_cmp_eq_u32 s3, 63
    s_cbranch_scc1 K1_PREP
    s_nop 7
    v_pk_mul_f32 v[128:129], v[128:129], s[6:7]
    v_pk_mul_f32 v[130:131], v[130:131], s[6:7]
    v_pk_mul_f32 v[132:133], v[132:133], s[6:7]
    v_pk_mul_f32 v[134:135], v[134:135], s[6:7]
    v_pk_mul_f32 v[136:137], v[136:137], s[6:7]
    v_pk_mul_f32 v[138:139], v[138:139], s[6:7]
    v_pk_mul_f32 v[140:141], v[140:141], s[6:7]
    v_pk_mul_f32 v[142:143], v[142:143], s[6:7]
    v_cvt_pk_bf16_f32 v16, v128, v129
    v_cvt_pk_bf16_f32 v17, v130, v131
    v_cvt_pk_bf16_f32 v18, v132, v133
    v_cvt_pk_bf16_f32 v19, v134, v135
    ds_write_b128 v14, v[16:19]
    v_cvt_pk_bf16_f32 v20, v136, v137
    v_cvt_pk_bf16_f32 v21, v138, v139
    v_cvt_pk_bf16_f32 v22, v140, v141
    v_cvt_pk_bf16_f32 v23, v142, v143
    ds_write_b128 v15, v[20:23]
    v_pk_mul_f32 v[144:145], v[144:145], s[6:7]
    v_pk_mul_f32 v[146:147], v[146:147], s[6:7]
    v_pk_mul_f32 v[148:149], v[148:149], s[6:7]
    v_pk_mul_f32 v[150:151], v[150:151], s[6:7]
    v_pk_mul_f32 v[152:153], v[152:153], s[6:7]
    v_pk_mul_f32 v[154:155], v[154:155], s[6:7]
    v_pk_mul_f32 v[156:157], v[156:157], s[6:7]
    v_pk_mul_f32 v[158:159], v[158:159], s[6:7]
    v_cvt_pk_bf16_f32 v96, v144, v145
    v_cvt_pk_bf16_f32 v97, v146, v147
    v_cvt_pk_bf16_f32 v98, v148, v149
    v_cvt_pk_bf16_f32 v99, v150, v151
    ds_write_b128 v6, v[96:99]
    v_cvt_pk_bf16_f32 v100, v152, v153
    v_cvt_pk_bf16_f32 v101, v154, v155
    v_cvt_pk_bf16_f32 v102, v156, v157
    v_cvt_pk_bf16_f32 v103, v158, v159
    ds_write_b128 v7, v[100:103]
    ds_read_b128 v[32:35], v2 offset:0
    ds_read_b128 v[36:39], v2 offset:1024
    ds_read_b128 v[40:43], v2 offset:2048
    ds_read_b128 v[44:47], v2 offset:3072
    s_waitcnt lgkmcnt(3)
    buffer_store_dwordx4 v[32:35], v3, s[32:35], s52 offen offset:0 sc0 sc1
    s_waitcnt lgkmcnt(2)
    buffer_store_dwordx4 v[36:39], v3, s[32:35], s52 offen offset:2048 sc0 sc1
    s_waitcnt lgkmcnt(1)
    buffer_store_dwordx4 v[40:43], v3, s[32:35], s53 offen offset:0 sc0 sc1
    s_waitcnt lgkmcnt(0)
    buffer_store_dwordx4 v[44:47], v3, s[32:35], s53 offen offset:2048 sc0 sc1
    s_endpgm
K1_PREP:
    s_mov_b32 s32, s24
    s_mov_b32 s33, s25
    s_mov_b32 s34, 10027008
    s_cmp_ge_u32 s27, 2
    s_cbranch_scc1 K1_END
    s_lshl_b32 s6, s26, 14
    s_add_u32 s4, s6, 9961472
    v_lshlrev_b32 v2, 4, v1
    v_lshrrev_b32 v3, 2, v1
    v_xor_b32 v3, v3, v1
    v_bfe_u32 v3, v3, 2, 1
    v_mul_u32_u24 v3, 20, v3
    v_xor_b32 v2, v3, v1
    v_lshlrev_b32 v2, 4, v2
    buffer_store_dwordx4 v[32:35], v2, s[32:35], s4 offen offset:0 sc0 sc1
    buffer_store_dwordx4 v[36:39], v2, s[32:35], s4 offen offset:1024 sc0 sc1
    buffer_store_dwordx4 v[40:43], v2, s[32:35], s4 offen offset:2048 sc0 sc1
    buffer_store_dwordx4 v[44:47], v2, s[32:35], s4 offen offset:3072 sc0 sc1
    s_add_u32 s4, s4, 4096
    buffer_store_dwordx4 v[48:51], v2, s[32:35], s4 offen offset:0 sc0 sc1
    buffer_store_dwordx4 v[52:55], v2, s[32:35], s4 offen offset:1024 sc0 sc1
    buffer_store_dwordx4 v[56:59], v2, s[32:35], s4 offen offset:2048 sc0 sc1
    buffer_store_dwordx4 v[60:63], v2, s[32:35], s4 offen offset:3072 sc0 sc1
    s_add_u32 s4, s4, 4096
    buffer_store_dwordx4 v[64:67], v2, s[32:35], s4 offen offset:0 sc0 sc1
    buffer_store_dwordx4 v[68:71], v2, s[32:35], s4 offen offset:1024 sc0 sc1
    buffer_store_dwordx4 v[72:75], v2, s[32:35], s4 offen offset:2048 sc0 sc1
    buffer_store_dwordx4 v[76:79], v2, s[32:35], s4 offen offset:3072 sc0 sc1
    s_add_u32 s4, s4, 4096
    buffer_store_dwordx4 v[80:83], v2, s[32:35], s4 offen offset:0 sc0 sc1
    buffer_store_dwordx4 v[84:87], v2, s[32:35], s4 offen offset:1024 sc0 sc1
    buffer_store_dwordx4 v[88:91], v2, s[32:35], s4 offen offset:2048 sc0 sc1
    buffer_store_dwordx4 v[92:95], v2, s[32:35], s4 offen offset:3072 sc0 sc1
    s_endpgm
K1_SORT:
    s_mul_i32 s3, s2, 10000
    v_lshlrev_b32 v28, 4, v0
    v_add_u32 v1, s3, v28
    v_lshlrev_b32 v2, 1, v1
    s_mov_b32 s30, 640000
    s_mov_b32 s31, 0x00020000
    s_mov_b32 s38, 640000
    s_mov_b32 s39, 0x00020000
    s_mov_b32 s42, 1280000
    s_mov_b32 s43, 0x00020000
    s_movk_i32 s4, 625
    v_cmp_gt_u32 s[26:27], s4, v0
    v_lshlrev_b32 v3, 2, v0
    v_mov_b32 v30, 0
    v_mov_b32 v31, 1
    s_waitcnt lgkmcnt(0)
    s_mov_b32 s28, s14
    s_mov_b32 s29, s15
    buffer_load_dwordx4 v[4:7], v1, s[28:31], 0 offen
    s_mov_b32 s36, s12
    s_mov_b32 s37, s13
    s_mov_b32 s40, s10
    s_mov_b32 s41, s11
    ds_write_b32 v3, v30
    s_waitcnt lgkmcnt(0)
    s_barrier
    buffer_load_dwordx4 v[8:11], v1, s[36:39], 0 offen
    buffer_load_dwordx4 v[12:15], v2, s[40:43], 0 offen
    buffer_load_dwordx4 v[24:27], v2, s[40:43], 0 offen offset:16
    s_movk_i32 s5, 3355
    s_mov_b32 s6, 1280180
    v_and_b32 v3, 63, v0
    v_lshlrev_b32 v3, 5, v3
    s_mov_b32 s32, s24
    s_mov_b32 s33, s25
    s_mov_b32 s34, 10027008
    s_mov_b32 s35, 0x00020000
    s_mov_b64 exec, s[26:27]
    s_waitcnt vmcnt(3)
    v_mul_u32_u24 v4, s5, v4
    v_lshrrev_b32 v32, 16, v4
    v_lshlrev_b32 v32, 2, v32
    ds_add_rtn_u32 v36, v32, v31
    v_mul_u32_u24 v5, s5, v5
    v_lshrrev_b32 v33, 16, v5
    v_lshlrev_b32 v33, 2, v33
    ds_add_rtn_u32 v37, v33, v31
    v_mul_u32_u24 v6, s5, v6
    v_lshrrev_b32 v34, 16, v6
    v_lshlrev_b32 v34, 2, v34
    ds_add_rtn_u32 v38, v34, v31
    v_mul_u32_u24 v7, s5, v7
    v_lshrrev_b32 v35, 16, v7
    v_lshlrev_b32 v35, 2, v35
    ds_add_rtn_u32 v39, v35, v31
    v_and_b32 v4, 0xffff, v4
    v_mul_hi_u32_u24 v4, s6, v4
    v_lshlrev_b32 v4, 1, v4
    v_and_b32 v5, 0xffff, v5
    v_mul_hi_u32_u24 v5, s6, v5
    v_lshlrev_b32 v5, 1, v5
    v_and_b32 v6, 0xffff, v6
    v_mul_hi_u32_u24 v6, s6, v6
    v_lshlrev_b32 v6, 1, v6
    v_and_b32 v7, 0xffff, v7
    v_mul_hi_u32_u24 v7, s6, v7
    v_lshlrev_b32 v7, 1, v7
    v_cmp_gt_u32 vcc, 64, v0
    s_lshl_b32 s7, s2, 11
    s_add_u32 s7, s7, 9830400
    s_waitcnt lgkmcnt(0)
    s_barrier
    s_cbranch_vccz K1_S2
    ds_read_b128 v[48:51], v3
    ds_read_b128 v[52:55], v3 offset:16
    s_waitcnt lgkmcnt(0)
    v_add_u32 v49, v49, v48
    v_add_u32 v50, v50, v49
    v_add_u32 v51, v51, v50
    v_add_u32 v52, v52, v51
    v_add_u32 v53, v53, v52
    v_add_u32 v54, v54, v53
    v_add_u32 v55, v55, v54
    v_mov_b32 v56, v55
    s_nop 1
    v_add_u32_dpp v56, v56, v56 row_shr:1 row_mask:0xf bank_mask:0xf bound_ctrl:0
    s_nop 1
    v_add_u32_dpp v56, v56, v56 row_shr:2 row_mask:0xf bank_mask:0xf bound_ctrl:0
    s_nop 1
    v_add_u32_dpp v56, v56, v56 row_shr:4 row_mask:0xf bank_mask:0xf bound_ctrl:0
    s_nop 1
    v_add_u32_dpp v56, v56, v56 row_shr:8 row_mask:0xf bank_mask:0xf bound_ctrl:0
    s_nop 1
    v_add_u32_dpp v56, v56, v56 row_bcast:15 row_mask:0xa bank_mask:0xf
    s_nop 1
    v_add_u32_dpp v56, v56, v56 row_bcast:31 row_mask:0xc bank_mask:0xf
    v_sub_u32 v56, v56, v55
    v_add_u32 v57, v56, v48
    v_add_u32 v58, v56, v49
    v_add_u32 v59, v56, v50
    v_add_u32 v60, v56, v51
    v_add_u32 v61, v56, v52
    v_add_u32 v62, v56, v53
    v_add_u32 v63, v56, v54
    v_add_u32 v64, v56, v55
    ds_write_b128 v3, v[56:59] offset:4096
    ds_write_b128 v3, v[60:63] offset:4112
    v_lshl_or_b32 v48, v57, 16, v56
    v_lshl_or_b32 v49, v58, 16, v57
    v_lshl_or_b32 v50, v59, 16, v58
    v_lshl_or_b32 v51, v60, 16, v59
    v_lshl_or_b32 v52, v61, 16, v60
    v_lshl_or_b32 v53, v62, 16, v61
    v_lshl_or_b32 v54, v63, 16, v62
    v_lshl_or_b32 v55, v64, 16, v63
    s_waitcnt lgkmcnt(0)
K1_S2:
    s_barrier
    ds_read_b32 v40, v32 offset:4096
    ds_read_b32 v41, v33 offset:4096
    ds_read_b32 v42, v34 offset:4096
    ds_read_b32 v43, v35 offset:4096
    s_mul_i32 s3, s2, 30000
    s_add_u32 s3, s3, 7864320
    s_movk_i32 s4, 8192
    s_waitcnt vmcnt(2)
    v_lshl_or_b32 v4, v8, 8, v4
    v_lshl_or_b32 v5, v9, 8, v5
    v_lshl_or_b32 v6, v10, 8, v6
    v_lshl_or_b32 v7, v11, 8, v7
    s_waitcnt lgkmcnt(3)
    v_add_u32 v40, v40, v36
    v_mad_u32_u24 v40, v40, 12, s4
    s_waitcnt vmcnt(1)
    ds_write2_b32 v40, v12, v13 offset1:1
    ds_write_b32 v40, v4 offset:8
    s_waitcnt lgkmcnt(4)
    v_add_u32 v41, v41, v37
    v_mad_u32_u24 v41, v41, 12, s4
    ds_write2_b32 v41, v14, v15 offset1:1
    ds_write_b32 v41, v5 offset:8
    s_waitcnt lgkmcnt(5)
    v_add_u32 v42, v42, v38
    v_mad_u32_u24 v42, v42, 12, s4
    s_waitcnt vmcnt(0)
    ds_write2_b32 v42, v24, v25 offset1:1
    ds_write_b32 v42, v6 offset:8
    s_waitcnt lgkmcnt(6)
    v_add_u32 v43, v43, v39
    v_mad_u32_u24 v43, v43, 12, s4
    ds_write2_b32 v43, v26, v27 offset1:1
    ds_write_b32 v43, v7 offset:8
    s_mov_b64 exec, -1
    s_cbranch_vccz K1_S3
    buffer_store_dwordx4 v[48:51], v3, s[32:35], s7 offen sc0 sc1
    buffer_store_dwordx4 v[52:55], v3, s[32:35], s7 offen offset:16 sc0 sc1
K1_S3:
    s_movk_i32 s4, 595
    v_cmp_gt_u32 vcc, s4, v0
    s_add_u32 s5, s3, 10240
    s_add_u32 s6, s3, 20480
    s_waitcnt lgkmcnt(0)
    s_barrier
    ds_read_b128 v[4:7], v28 offset:8192
    ds_read_b128 v[8:11], v28 offset:18432
    ds_read_b128 v[12:15], v28 offset:28672
    s_waitcnt lgkmcnt(2)
    buffer_store_dwordx4 v[4:7], v28, s[32:35], s3 offen sc0 sc1
    s_waitcnt lgkmcnt(1)
    buffer_store_dwordx4 v[8:11], v28, s[32:35], s5 offen sc0 sc1
    s_mov_b64 exec, vcc
    s_waitcnt lgkmcnt(0)
    buffer_store_dwordx4 v[12:15], v28, s[32:35], s6 offen sc0 sc1
K1_END:
    s_endpgm
.globl gather_scatter__mpnn_edge_mlp__graph_kernel
.p2align 8
.type gather_scatter__mpnn_edge_mlp__graph_kernel,@function
gather_scatter__mpnn_edge_mlp__graph_kernel:
    s_cmpk_ge_u32 s2, 512
    s_cbranch_scc1 K2_END
    s_load_dwordx2 s[24:25], s[0:1], 64
    s_load_dwordx2 s[16:17], s[0:1], 32
    s_load_dwordx2 s[20:21], s[0:1], 48
    v_lshrrev_b32 v13, 6, v0
    v_and_b32 v1, 63, v0
    s_and_b32 s44, s2, 7
    v_readfirstlane_b32 s47, v13
    s_lshl_b32 s44, s44, 6
    s_lshr_b32 s43, s2, 3
    s_add_u32 s44, s44, s43
    v_lshrrev_b32 v96, 2, v0
    v_lshlrev_b32 v97, 11, v96
    s_lshl_b32 s3, s44, 2
    s_add_u32 s3, s3, 9830400
    s_mov_b32 s34, 10027008
    s_mov_b32 s35, 0x00020000
    s_mul_i32 s45, s44, 1280169
    s_add_u32 s46, s45, 1345704
    s_add_u32 s45, s45, 65535
    s_lshr_b32 s45, s45, 16
    s_lshr_b32 s46, s46, 16
    s_min_u32 s46, s46, 10000
    s_sub_u32 s46, s46, s45
    s_movk_i32 s4, 30000
    v_mul_u32_u24 v249, s4, v96
    v_bfrev_b32 v254, 2
    v_lshrrev_b32 v13, 5, v1
    v_bfe_u32 v252, v1, 2, 2
    v_and_b32 v253, 3, v1
    v_and_b32 v248, 31, v1
    s_lshl_b32 s5, s45, 8
    s_lshl_b32 s4, s47, 6
    s_add_u32 s5, s5, s4
    v_lshrrev_b32 v98, 2, v1
    v_lshlrev_b32 v140, 4, v253
    v_lshl_or_b32 v140, v98, 8, v140
    v_lshlrev_b32 v102, 4, v13
    v_lshl_or_b32 v152, v248, 8, v102
    s_add_u32 s6, s5, 2625536
    s_add_u32 s8, s5, 2628608
    s_add_u32 s9, s5, 5246976
    s_lshl_b32 s7, s47, 11
    s_add_u32 s7, s7, 57344
    s_mov_b32 m0, s7
    s_add_u32 s4, s4, 65536
    v_lshl_add_u32 v141, v248, 1, s4
    s_lshl_b32 s53, s47, 13
    v_lshlrev_b32 v250, 4, v0
    v_mov_b32 v251, 65536
    s_mov_b32 s42, 66560
    s_mov_b32 s43, 0x00020000
    v_mul_u32_u24 v5, 48, v248
    v_lshl_add_u32 v4, v13, 4, v5
    v_add_u32 v4, 32768, v4
    v_add_u32 v5, 32800, v5
    v_lshl_add_u32 v6, v13, 2, v252
    v_mul_u32_u24 v6, 48, v6
    v_bfe_u32 v88, v1, 4, 1
    v_lshl_or_b32 v88, v88, 2, v253
    v_lshl_add_u32 v6, v88, 3, v6
    v_add_u32 v6, 32768, v6
    v_and_b32 v7, 60, v1
    v_add_u32 v7, 53248, v7
    v_xor_b32 v2, v252, v13
    v_lshlrev_b32 v2, 4, v2
    v_lshl_or_b32 v2, v248, 6, v2
    v_add_u32 v2, s53, v2
    v_xor_b32 v3, 32, v2
    v_mov_b32 v80, 0
    v_mov_b32 v104, 0
    v_mov_b32 v81, 0
    v_mov_b32 v105, 0
    v_mov_b32 v82, 0
    v_mov_b32 v106, 0
    v_mov_b32 v83, 0
    v_mov_b32 v107, 0
    v_mov_b32 v84, 0
    v_mov_b32 v108, 0
    v_mov_b32 v85, 0
    v_mov_b32 v109, 0
    v_mov_b32 v86, 0
    v_mov_b32 v110, 0
    v_mov_b32 v87, 0
    v_mov_b32 v111, 0
    s_mov_b32 s67, 0
    s_waitcnt lgkmcnt(0)
    s_mov_b32 s32, s24
    s_mov_b32 s33, s25
    buffer_load_dword v11, v97, s[32:35], s3 offen
    s_mov_b32 s40, s16
    s_mov_b32 s41, s17
    buffer_load_ushort v244, v141, s[40:43], 0 offen offset:0
    buffer_load_ushort v245, v141, s[40:43], 0 offen offset:256
    buffer_load_ushort v246, v141, s[40:43], 0 offen offset:512
    buffer_load_ushort v247, v141, s[40:43], 0 offen offset:768
    s_mov_b32 s36, s20
    s_mov_b32 s37, s21
    s_mov_b32 s38, 2560000
    s_mov_b32 s39, 0x00020000
    ds_write_b128 v250, v[80:83] offset:32768
    ds_write_b128 v250, v[80:83] offset:36864
    ds_write_b128 v250, v[80:83] offset:40960
    ds_write_b128 v250, v[80:83] offset:45056
    ds_write_b128 v250, v[80:83] offset:49152
    ds_write_b128 v250, v[80:83] offset:53248
    ds_write_b64 v251, v[80:81]
    s_mov_b32 s3, 7864320
    s_waitcnt lgkmcnt(0)
    s_barrier
    s_waitcnt vmcnt(4)
    v_and_b32 v10, 0xffff, v11
    v_lshrrev_b32 v11, 16, v11
    v_add_u32 v10, v10, v253
K2_ROUND:
    v_sub_u32 v97, v11, v10
    v_mad_u32_u24 v96, v10, 12, v249
    v_cmp_lt_i32 s[56:57], 0, v97
    v_cmp_lt_i32 s[58:59], 4, v97
    v_cmp_lt_i32 s[60:61], 8, v97
    v_cmp_lt_i32 s[62:63], 12, v97
    v_cmp_lt_i32 s[64:65], 16, v97
    v_cndmask_b32 v98, v254, v96, s[56:57]
    buffer_load_dwordx3 v[224:226], v98, s[32:35], s3 offen offset:0
    v_cndmask_b32 v99, v254, v96, s[58:59]
    buffer_load_dwordx3 v[228:230], v99, s[32:35], s3 offen offset:48
    v_cndmask_b32 v100, v254, v96, s[60:61]
    buffer_load_dwordx3 v[232:234], v100, s[32:35], s3 offen offset:96
    v_cndmask_b32 v101, v254, v96, s[62:63]
    buffer_load_dwordx3 v[236:238], v101, s[32:35], s3 offen offset:144
    v_cndmask_b32 v102, v254, v96, s[64:65]
    buffer_load_dwordx3 v[240:242], v102, s[32:35], s3 offen offset:192
    s_cmp_lg_u32 s67, 0
    s_cbranch_scc1 K2_NOQ
    buffer_load_dwordx4 v140, s[32:35], s6 offen lds
    s_mov_b64 exec, 0xffff
    buffer_load_dwordx4 v140, s[32:35], s8 offen offset:1024 lds
    s_mov_b64 exec, -1
K2_Q1:
    s_mov_b64 exec, 1
    s_bcnt1_i32_b64 s11, s[56:57]
    s_bcnt1_i32_b64 s12, s[58:59]
    s_bcnt1_i32_b64 s13, s[60:61]
    s_bcnt1_i32_b64 s14, s[62:63]
    s_bcnt1_i32_b64 s15, s[64:65]
    s_add_u32 s12, s12, s11
    s_add_u32 s13, s13, s12
    s_add_u32 s14, s14, s13
    s_add_u32 s15, s15, s14
    v_mov_b32 v96, s15
    ds_add_rtn_u32 v96, v251, v96
    s_mov_b64 exec, -1
    v_mbcnt_lo_u32_b32 v227, s56, 0
    v_mbcnt_hi_u32_b32 v227, s57, v227
    v_mbcnt_lo_u32_b32 v231, s58, 0
    v_mbcnt_hi_u32_b32 v231, s59, v231
    v_mbcnt_lo_u32_b32 v235, s60, 0
    v_mbcnt_hi_u32_b32 v235, s61, v235
    v_mbcnt_lo_u32_b32 v239, s62, 0
    v_mbcnt_hi_u32_b32 v239, s63, v239
    v_mbcnt_lo_u32_b32 v243, s64, 0
    v_mbcnt_hi_u32_b32 v243, s65, v243
    s_waitcnt lgkmcnt(0)
    v_readfirstlane_b32 s10, v96
    v_mov_b32 v97, 0x3f80
    s_movk_i32 s4, 416
    s_add_u32 s11, s11, s10
    s_add_u32 s12, s12, s10
    s_add_u32 s13, s13, s10
    s_add_u32 s14, s14, s10
    v_add_u32 v227, s10, v227
    v_cmp_gt_u32 vcc, s4, v227
    s_and_b64 s[56:57], vcc, s[56:57]
    v_mul_u32_u24 v98, 48, v227
    v_lshlrev_b32 v227, 2, v227
    v_add_u32 v231, s11, v231
    v_cmp_gt_u32 vcc, s4, v231
    s_and_b64 s[58:59], vcc, s[58:59]
    v_mul_u32_u24 v99, 48, v231
    v_lshlrev_b32 v231, 2, v231
    v_add_u32 v235, s12, v235
    v_cmp_gt_u32 vcc, s4, v235
    s_and_b64 s[60:61], vcc, s[60:61]
    v_mul_u32_u24 v100, 48, v235
    v_lshlrev_b32 v235, 2, v235
    v_add_u32 v239, s13, v239
    v_cmp_gt_u32 vcc, s4, v239
    s_and_b64 s[62:63], vcc, s[62:63]
    v_mul_u32_u24 v101, 48, v239
    v_lshlrev_b32 v239, 2, v239
    v_add_u32 v243, s14, v243
    v_cmp_gt_u32 vcc, s4, v243
    s_and_b64 s[64:65], vcc, s[64:65]
    v_mul_u32_u24 v102, 48, v243
    v_lshlrev_b32 v243, 2, v243
    v_bfe_u32 v130, v1, 4, 2
    v_xor_b32 v9, v253, v130
    s_lshl_b32 s4, s47, 6
    v_lshl_add_u32 v9, v9, 4, s4
    v_mov_b32 v15, v9
    s_add_u32 s68, s24, 4096
    s_addc_u32 s69, s25, 0
    s_or_b32 s69, s69, 0x1000000
    s_mov_b32 s70, 2621440
    s_mov_b32 s71, 0x00020000
    v_lshl_add_u32 v255, v13, 3, v252
    v_and_b32 v130, 1, v130
    v_lshl_or_b32 v130, v130, 2, v253
    v_lshlrev_b32 v130, 3, v130
    v_lshl_or_b32 v255, v255, 6, v130
    v_add_u32 v255, s7, v255
    v_mov_b32 v49, v9
    v_mov_b32 v51, v9
    v_mov_b32 v53, v9
    v_mov_b32 v55, v9
    s_mov_b64 exec, s[56:57]
    v_add_u32 v10, 4, v10
    s_waitcnt vmcnt(6)
    v_lshrrev_b32 v96, 8, v226
    ds_write_b32 v227, v96 offset:53248
    v_and_b32 v226, 0xff, v226
    v_add_u32 v226, v226, v98
    ds_write_b64 v98, v[224:225] offset:32808
    ds_write_b16 v226, v97 offset:32768
    s_mov_b64 exec, s[58:59]
    v_add_u32 v10, 4, v10
    s_waitcnt vmcnt(5)
    v_lshrrev_b32 v96, 8, v230
    ds_write_b32 v231, v96 offset:53248
    v_and_b32 v230, 0xff, v230
    v_add_u32 v230, v230, v99
    ds_write_b64 v99, v[228:229] offset:32808
    ds_write_b16 v230, v97 offset:32768
    s_mov_b64 exec, s[60:61]
    s_cbranch_execz K2_RB_DONE
    v_add_u32 v10, 4, v10
    s_waitcnt vmcnt(4)
    v_lshrrev_b32 v96, 8, v234
    ds_write_b32 v235, v96 offset:53248
    v_and_b32 v234, 0xff, v234
    v_add_u32 v234, v234, v100
    ds_write_b64 v100, v[232:233] offset:32808
    ds_write_b16 v234, v97 offset:32768
    s_mov_b64 exec, s[62:63]
    s_cbranch_execz K2_RB_DONE
    v_add_u32 v10, 4, v10
    s_waitcnt vmcnt(3)
    v_lshrrev_b32 v96, 8, v238
    ds_write_b32 v239, v96 offset:53248
    v_and_b32 v238, 0xff, v238
    v_add_u32 v238, v238, v101
    ds_write_b64 v101, v[236:237] offset:32808
    ds_write_b16 v238, v97 offset:32768
    s_mov_b64 exec, s[64:65]
    s_cbranch_execz K2_RB_DONE
    v_add_u32 v10, 4, v10
    s_waitcnt vmcnt(2)
    v_lshrrev_b32 v96, 8, v242
    ds_write_b32 v243, v96 offset:53248
    v_and_b32 v242, 0xff, v242
    v_add_u32 v242, v242, v102
    ds_write_b64 v102, v[240:241] offset:32808
    ds_write_b16 v242, v97 offset:32768
K2_RB_DONE:
    s_mov_b64 exec, -1
    v_cmp_lt_u32 vcc, v10, v11
    s_mov_b64 exec, vcc
    ds_write_b32 v251, v97 offset:4
    s_mov_b64 exec, -1
    s_waitcnt lgkmcnt(0)
    s_barrier
    ds_read_b32 v8, v7
    ds_read_b32 v14, v7 offset:64
    ds_read_b64 v[42:43], v251
    ds_read_b32 v48, v7 offset:128
    ds_read_b32 v50, v7 offset:192
    ds_read_b128 v[96:99], v4
    ds_read_b128 v[100:103], v5
    ds_read_b32 v52, v7 offset:256
    ds_read_b32 v54, v7 offset:320
    s_add_u32 m0, s53, 4096
    s_waitcnt lgkmcnt(8)
    buffer_load_dwordx4 v[8:9], s[68:71], 0 idxen offen lds
    s_add_u32 m0, s53, 5120
    s_waitcnt lgkmcnt(7)
    buffer_load_dwordx4 v[14:15], s[68:71], 0 idxen offen lds
    s_waitcnt lgkmcnt(6)
    v_readfirstlane_b32 s48, v42
    v_readfirstlane_b32 s51, v43
    s_min_u32 s48, s48, 416
    s_max_u32 s48, s48, 1
    s_add_u32 s4, s48, 31
    s_lshr_b32 s48, s4, 5
    s_sub_u32 s49, 13, s48
    s_bfe_u32 s50, s4, 0x10004
    s_xor_b32 s50, s50, 1
    s_and_b32 s4, s49, 1
    s_lshl_b32 s4, s4, 11
    s_add_u32 s52, s53, s4
    s_xor_b32 m0, s52, 0x800
    s_waitcnt lgkmcnt(5)
    buffer_load_dwordx4 v[48:49], s[68:71], 0 idxen offen lds
    s_xor_b32 m0, s52, 0xc00
    s_waitcnt lgkmcnt(4)
    buffer_load_dwordx4 v[50:51], s[68:71], 0 idxen offen lds
    s_mul_i32 s4, s49, 1536
    s_lshl_b32 s6, s49, 7
    s_waitcnt lgkmcnt(2)
    s_waitcnt vmcnt(4)
    ds_read_b64_tr_b16 v[120:121], v255
    ds_read_b64_tr_b16 v[122:123], v255 offset:256
    ds_read_b64_tr_b16 v[124:125], v255 offset:1024
    s_mov_b32 s18, 0xbfb8aa3b
    v_lshlrev_b32 v128, 16, v244
    v_mul_f32 v128, s18, v128
    v_lshlrev_b32 v129, 16, v245
    v_mul_f32 v129, s18, v129
    v_lshlrev_b32 v130, 16, v246
    v_mul_f32 v130, s18, v130
    v_lshlrev_b32 v131, 16, v247
    v_mul_f32 v131, s18, v131
    v_cvt_pk_bf16_f32 v132, v128, v129
    v_cvt_pk_bf16_f32 v133, v130, v131
    v_lshlrev_b32 v134, 16, v132
    v_and_b32 v135, 0xffff0000, v132
    v_lshlrev_b32 v136, 16, v133
    v_and_b32 v137, 0xffff0000, v133
    v_sub_f32 v128, v128, v134
    v_sub_f32 v129, v129, v135
    v_sub_f32 v130, v130, v136
    v_sub_f32 v131, v131, v137
    v_cmp_eq_u32 vcc, 0, v13
    v_cvt_pk_bf16_f32 v134, v128, v129
    v_cvt_pk_bf16_f32 v135, v130, v131
    v_cndmask_b32 v126, v134, v132, vcc
    v_cndmask_b32 v127, v135, v133, vcc
    s_waitcnt lgkmcnt(0)
    v_cndmask_b32 v124, 0, v124, vcc
    v_cndmask_b32 v125, 0, v125, vcc
    v_mfma_f32_32x32x16_bf16 v[16:31], v[96:99], v[120:123], 0
    s_nop 0
    v_mfma_f32_32x32x16_bf16 v[16:31], v[100:103], v[124:127], v[16:31]
    v_lshlrev_b32 v12, 4, v1
    s_add_u32 s54, s53, 9961472
    s_add_u32 s55, s54, 0x1000
    s_lshl_b32 s26, s47, 11
    s_add_u32 s26, s26, s54
    s_xor_b32 s28, s26, 2048
    s_xor_b32 s30, s26, 4096
    s_xor_b32 s66, s26, 6144
    s_cmp_lg_u32 s67, 0
    s_cbranch_scc1 K2_NOZ
    v_lshrrev_b32 v128, 1, v248
    v_lshlrev_b32 v129, 2, v13
    v_sub_u32 v128, v128, v129
    v_and_b32 v129, 1, v1
    v_lshlrev_b32 v129, 4, v129
    v_mov_b32 v130, 0x3f80
    v_lshlrev_b32 v129, v129, v130
    v_cmp_eq_u32 vcc, 0, v128
    v_mov_b32 v64, 0
    v_mov_b32 v65, 0
    v_cndmask_b32 v112, 0, v129, vcc
    v_cmp_eq_u32 vcc, 1, v128
    v_mov_b32 v66, 0
    v_mov_b32 v67, 0
    v_cndmask_b32 v113, 0, v129, vcc
    v_cmp_eq_u32 vcc, 2, v128
    v_mov_b32 v68, 0
    v_mov_b32 v69, 0
    v_cndmask_b32 v114, 0, v129, vcc
    v_cmp_eq_u32 vcc, 3, v128
    v_mov_b32 v70, 0
    v_mov_b32 v71, 0
    v_cndmask_b32 v115, 0, v129, vcc
    v_cmp_eq_u32 vcc, 8, v128
    v_mov_b32 v72, 0
    v_mov_b32 v73, 0
    v_cndmask_b32 v116, 0, v129, vcc
    v_cmp_eq_u32 vcc, 9, v128
    v_mov_b32 v74, 0
    v_mov_b32 v75, 0
    v_cndmask_b32 v117, 0, v129, vcc
    v_cmp_eq_u32 vcc, 10, v128
    v_mov_b32 v76, 0
    v_mov_b32 v77, 0
    v_cndmask_b32 v118, 0, v129, vcc
    v_cmp_eq_u32 vcc, 11, v128
    v_mov_b32 v78, 0
    v_mov_b32 v79, 0
    v_cndmask_b32 v119, 0, v129, vcc
    s_mov_b32 s67, 1
K2_NOZ:
    v_subrev_u32 v4, s4, v4
    v_subrev_u32 v5, s4, v5
    v_subrev_u32 v6, s4, v6
    v_subrev_u32 v7, s6, v7
    s_mov_b32 m0, s52
    s_waitcnt vmcnt(2) lgkmcnt(0)
    ds_read_b128 v[88:91], v2 offset:4096
    ds_read_b128 v[92:95], v3 offset:4096
    buffer_load_dwordx4 v[52:53], s[68:71], 0 idxen offen lds
    s_add_u32 m0, s52, 0x400
    s_cmp_lt_u32 s49, 11
    buffer_load_dwordx4 v[54:55], s[68:71], 0 idxen offen lds
    s_cbranch_scc1 K2_NWU
    buffer_load_dwordx4 v[160:163], v12, s[32:35], s26 offen offset:0
    buffer_load_dwordx4 v[164:167], v12, s[32:35], s26 offen offset:1024
    buffer_load_dwordx4 v[168:171], v12, s[32:35], s28 offen offset:0
    buffer_load_dwordx4 v[172:175], v12, s[32:35], s28 offen offset:1024
    buffer_load_dwordx4 v[176:179], v12, s[32:35], s30 offen offset:0
    buffer_load_dwordx4 v[180:183], v12, s[32:35], s30 offen offset:1024
    buffer_load_dwordx4 v[184:187], v12, s[32:35], s66 offen offset:0
    buffer_load_dwordx4 v[188:191], v12, s[32:35], s66 offen offset:1024
    buffer_load_dwordx4 v[144:147], v152, s[36:39], s5 offen
    buffer_load_dwordx4 v[148:151], v152, s[36:39], s5 offen offset:32
K2_NWU:
    s_waitcnt lgkmcnt(0)
    s_bitcmp1_b32 s49, 0
    s_cbranch_scc1 K2_ODDA
    v_mfma_f32_32x32x16_bf16 v[16:31], v[88:91], v[112:115], v[16:31]
    v_mfma_f32_32x32x16_bf16 v[16:31], v[92:95], v[116:119], v[16:31]
    s_nop 7
    s_cmp_eq_u32 s49, 2
    s_cbranch_scc1 K2_T2A
    s_cmp_eq_u32 s49, 4
    s_cbranch_scc1 K2_T4A
    s_cmp_eq_u32 s49, 0
    s_cbranch_scc1 K2_T0A
    s_cmp_eq_u32 s49, 6
    s_cbranch_scc1 K2_T6A
    s_cmp_eq_u32 s49, 8
    s_cbranch_scc1 K2_T8A
    s_cmp_eq_u32 s49, 10
    s_cbranch_scc1 K2_T10A
    s_branch K2_T12A
K2_ODDA:
    v_mfma_f32_32x32x16_bf16 v[32:47], v[88:91], v[112:115], v[16:31]
    v_mfma_f32_32x32x16_bf16 v[32:47], v[92:95], v[116:119], v[32:47]
    s_nop 7
    s_cmp_eq_u32 s49, 3
    s_cbranch_scc1 K2_T3A
    s_cmp_eq_u32 s49, 1
    s_cbranch_scc1 K2_T1A
    s_cmp_eq_u32 s49, 5
    s_cbranch_scc1 K2_T5A
    s_cmp_eq_u32 s49, 7
    s_cbranch_scc1 K2_T7A
    s_cmp_eq_u32 s49, 9
    s_cbranch_scc1 K2_T9A
    s_branch K2_T11A
K2_T0A:
    s_waitcnt vmcnt(2) lgkmcnt(0)
    ds_read_b128 v[88:91], v2 offset:2048
    ds_read_b128 v[92:95], v3 offset:2048
    ds_read_b128 v[96:99], v4 offset:1536
    ds_read_b128 v[100:103], v5 offset:1536
    ds_read_b32 v8, v7 offset:384
    ds_read_b32 v14, v7 offset:448
    s_add_u32 m0, s53, 2048
    s_setprio 3
    v_mfma_f32_32x32x16_bf16 v[64:79], v[80:83], v[104:107], v[64:79]
    v_exp_f32 v48, v16
    v_exp_f32 v49, v17
    v_exp_f32 v50, v18
    v_mfma_f32_32x32x16_bf16 v[64:79], v[84:87], v[108:111], v[64:79]
    v_exp_f32 v51, v19
    v_exp_f32 v52, v20
    v_exp_f32 v53, v21
    v_exp_f32 v54, v22
    v_exp_f32 v55, v23
    v_exp_f32 v56, v24
    v_exp_f32 v57, v25
    v_exp_f32 v58, v26
    v_exp_f32 v59, v27
    v_exp_f32 v60, v28
    v_exp_f32 v61, v29
    v_exp_f32 v62, v30
    v_exp_f32 v63, v31
    v_pk_add_f32 v[48:49], v[48:49], 1.0 op_sel_hi:[1,0]
    v_pk_add_f32 v[50:51], v[50:51], 1.0 op_sel_hi:[1,0]
    v_pk_add_f32 v[52:53], v[52:53], 1.0 op_sel_hi:[1,0]
    v_pk_add_f32 v[54:55], v[54:55], 1.0 op_sel_hi:[1,0]
    v_pk_add_f32 v[56:57], v[56:57], 1.0 op_sel_hi:[1,0]
    v_pk_add_f32 v[58:59], v[58:59], 1.0 op_sel_hi:[1,0]
    v_pk_add_f32 v[60:61], v[60:61], 1.0 op_sel_hi:[1,0]
    v_pk_add_f32 v[62:63], v[62:63], 1.0 op_sel_hi:[1,0]
    s_waitcnt lgkmcnt(0)
    buffer_load_dwordx4 v[8:9], s[68:71], 0 idxen offen lds
    s_add_u32 m0, s53, 3072
    ds_read_b64_tr_b16 v[104:105], v6 offset:0
    buffer_load_dwordx4 v[14:15], s[68:71], 0 idxen offen lds
    ds_read_b64_tr_b16 v[106:107], v6 offset:384
    ds_read_b64_tr_b16 v[108:109], v6 offset:768
    ds_read_b64_tr_b16 v[110:111], v6 offset:1152
    v_mfma_f32_32x32x16_bf16 v[32:47], v[88:91], v[112:115], 0
    v_rcp_f32 v48, v48
    v_rcp_f32 v49, v49
    v_rcp_f32 v50, v50
    v_mfma_f32_32x32x16_bf16 v[32:47], v[92:95], v[116:119], v[32:47]
    v_rcp_f32 v51, v51
    v_rcp_f32 v52, v52
    v_rcp_f32 v53, v53
    v_mfma_f32_32x32x16_bf16 v[32:47], v[96:99], v[120:123], v[32:47]
    v_rcp_f32 v54, v54
    v_rcp_f32 v55, v55
    v_rcp_f32 v56, v56
    v_mfma_f32_32x32x16_bf16 v[32:47], v[100:103], v[124:127], v[32:47]
    v_rcp_f32 v57, v57
    v_rcp_f32 v58, v58
    v_rcp_f32 v59, v59
    v_rcp_f32 v60, v60
    v_rcp_f32 v61, v61
    v_rcp_f32 v62, v62
    v_rcp_f32 v63, v63
    v_pk_mul_f32 v[48:49], v[48:49], v[16:17]
    v_pk_mul_f32 v[50:51], v[50:51], v[18:19]
    v_pk_mul_f32 v[52:53], v[52:53], v[20:21]
    v_pk_mul_f32 v[54:55], v[54:55], v[22:23]
    v_pk_mul_f32 v[56:57], v[56:57], v[24:25]
    v_pk_mul_f32 v[58:59], v[58:59], v[26:27]
    v_pk_mul_f32 v[60:61], v[60:61], v[28:29]
    v_pk_mul_f32 v[62:63], v[62:63], v[30:31]
    v_cvt_pk_bf16_f32 v80, v48, v49
    v_cvt_pk_bf16_f32 v81, v50, v51
    v_cvt_pk_bf16_f32 v82, v52, v53
    v_cvt_pk_bf16_f32 v83, v54, v55
    v_cvt_pk_bf16_f32 v84, v56, v57
    v_cvt_pk_bf16_f32 v85, v58, v59
    v_cvt_pk_bf16_f32 v86, v60, v61
    v_cvt_pk_bf16_f32 v87, v62, v63
K2_T1A:
    s_waitcnt vmcnt(2) lgkmcnt(0)
    ds_read_b128 v[88:91], v2 offset:0
    ds_read_b128 v[92:95], v3 offset:0
    ds_read_b128 v[96:99], v4 offset:3072
    ds_read_b128 v[100:103], v5 offset:3072
    ds_read_b32 v8, v7 offset:512
    ds_read_b32 v14, v7 offset:576
    s_add_u32 m0, s53, 0
    s_setprio 3
    v_mfma_f32_32x32x16_bf16 v[64:79], v[80:83], v[104:107], v[64:79]
    v_exp_f32 v48, v32
    v_exp_f32 v49, v33
    v_exp_f32 v50, v34
    v_mfma_f32_32x32x16_bf16 v[64:79], v[84:87], v[108:111], v[64:79]
    v_exp_f32 v51, v35
    v_exp_f32 v52, v36
    v_exp_f32 v53, v37
    v_exp_f32 v54, v38
    v_exp_f32 v55, v39
    v_exp_f32 v56, v40
    v_exp_f32 v57, v41
    v_exp_f32 v58, v42
    v_exp_f32 v59, v43
    v_exp_f32 v60, v44
    v_exp_f32 v61, v45
    v_exp_f32 v62, v46
    v_exp_f32 v63, v47
    v_pk_add_f32 v[48:49], v[48:49], 1.0 op_sel_hi:[1,0]
    v_pk_add_f32 v[50:51], v[50:51], 1.0 op_sel_hi:[1,0]
    v_pk_add_f32 v[52:53], v[52:53], 1.0 op_sel_hi:[1,0]
    v_pk_add_f32 v[54:55], v[54:55], 1.0 op_sel_hi:[1,0]
    v_pk_add_f32 v[56:57], v[56:57], 1.0 op_sel_hi:[1,0]
    v_pk_add_f32 v[58:59], v[58:59], 1.0 op_sel_hi:[1,0]
    v_pk_add_f32 v[60:61], v[60:61], 1.0 op_sel_hi:[1,0]
    v_pk_add_f32 v[62:63], v[62:63], 1.0 op_sel_hi:[1,0]
    s_waitcnt lgkmcnt(0)
    buffer_load_dwordx4 v[8:9], s[68:71], 0 idxen offen lds
    s_add_u32 m0, s53, 1024
    ds_read_b64_tr_b16 v[104:105], v6 offset:1536
    buffer_load_dwordx4 v[14:15], s[68:71], 0 idxen offen lds
    ds_read_b64_tr_b16 v[106:107], v6 offset:1920
    ds_read_b64_tr_b16 v[108:109], v6 offset:2304
    ds_read_b64_tr_b16 v[110:111], v6 offset:2688
    v_mfma_f32_32x32x16_bf16 v[16:31], v[88:91], v[112:115], 0
    v_rcp_f32 v48, v48
    v_rcp_f32 v49, v49
    v_rcp_f32 v50, v50
    v_mfma_f32_32x32x16_bf16 v[16:31], v[92:95], v[116:119], v[16:31]
    v_rcp_f32 v51, v51
    v_rcp_f32 v52, v52
    v_rcp_f32 v53, v53
    v_mfma_f32_32x32x16_bf16 v[16:31], v[96:99], v[120:123], v[16:31]
    v_rcp_f32 v54, v54
    v_rcp_f32 v55, v55
    v_rcp_f32 v56, v56
    v_mfma_f32_32x32x16_bf16 v[16:31], v[100:103], v[124:127], v[16:31]
    v_rcp_f32 v57, v57
    v_rcp_f32 v58, v58
    v_rcp_f32 v59, v59
    v_rcp_f32 v60, v60
    v_rcp_f32 v61, v61
    v_rcp_f32 v62, v62
    v_rcp_f32 v63, v63
    v_pk_mul_f32 v[48:49], v[48:49], v[32:33]
    v_pk_mul_f32 v[50:51], v[50:51], v[34:35]
    v_pk_mul_f32 v[52:53], v[52:53], v[36:37]
    v_pk_mul_f32 v[54:55], v[54:55], v[38:39]
    v_pk_mul_f32 v[56:57], v[56:57], v[40:41]
    v_pk_mul_f32 v[58:59], v[58:59], v[42:43]
    v_pk_mul_f32 v[60:61], v[60:61], v[44:45]
    v_pk_mul_f32 v[62:63], v[62:63], v[46:47]
    v_cvt_pk_bf16_f32 v80, v48, v49
    v_cvt_pk_bf16_f32 v81, v50, v51
    v_cvt_pk_bf16_f32 v82, v52, v53
    v_cvt_pk_bf16_f32 v83, v54, v55
    v_cvt_pk_bf16_f32 v84, v56, v57
    v_cvt_pk_bf16_f32 v85, v58, v59
    v_cvt_pk_bf16_f32 v86, v60, v61
    v_cvt_pk_bf16_f32 v87, v62, v63
K2_T2A:
    s_waitcnt vmcnt(2) lgkmcnt(0)
    ds_read_b128 v[88:91], v2 offset:2048
    ds_read_b128 v[92:95], v3 offset:2048
    ds_read_b128 v[96:99], v4 offset:4608
    ds_read_b128 v[100:103], v5 offset:4608
    ds_read_b32 v8, v7 offset:640
    ds_read_b32 v14, v7 offset:704
    s_add_u32 m0, s53, 2048
    s_setprio 3
    v_mfma_f32_32x32x16_bf16 v[64:79], v[80:83], v[104:107], v[64:79]
    v_exp_f32 v48, v16
    v_exp_f32 v49, v17
    v_exp_f32 v50, v18
    v_mfma_f32_32x32x16_bf16 v[64:79], v[84:87], v[108:111], v[64:79]
    v_exp_f32 v51, v19
    v_exp_f32 v52, v20
    v_exp_f32 v53, v21
    v_exp_f32 v54, v22
    v_exp_f32 v55, v23
    v_exp_f32 v56, v24
    v_exp_f32 v57, v25
    v_exp_f32 v58, v26
    v_exp_f32 v59, v27
    v_exp_f32 v60, v28
    v_exp_f32 v61, v29
    v_exp_f32 v62, v30
    v_exp_f32 v63, v31
    v_pk_add_f32 v[48:49], v[48:49], 1.0 op_sel_hi:[1,0]
    v_pk_add_f32 v[50:51], v[50:51], 1.0 op_sel_hi:[1,0]
    v_pk_add_f32 v[52:53], v[52:53], 1.0 op_sel_hi:[1,0]
    v_pk_add_f32 v[54:55], v[54:55], 1.0 op_sel_hi:[1,0]
    v_pk_add_f32 v[56:57], v[56:57], 1.0 op_sel_hi:[1,0]
    v_pk_add_f32 v[58:59], v[58:59], 1.0 op_sel_hi:[1,0]
    v_pk_add_f32 v[60:61], v[60:61], 1.0 op_sel_hi:[1,0]
    v_pk_add_f32 v[62:63], v[62:63], 1.0 op_sel_hi:[1,0]
    s_waitcnt lgkmcnt(0)
    buffer_load_dwordx4 v[8:9], s[68:71], 0 idxen offen lds
    s_add_u32 m0, s53, 3072
    ds_read_b64_tr_b16 v[104:105], v6 offset:3072
    buffer_load_dwordx4 v[14:15], s[68:71], 0 idxen offen lds
    ds_read_b64_tr_b16 v[106:107], v6 offset:3456
    ds_read_b64_tr_b16 v[108:109], v6 offset:3840
    ds_read_b64_tr_b16 v[110:111], v6 offset:4224
    v_mfma_f32_32x32x16_bf16 v[32:47], v[88:91], v[112:115], 0
    v_rcp_f32 v48, v48
    v_rcp_f32 v49, v49
    v_rcp_f32 v50, v50
    v_mfma_f32_32x32x16_bf16 v[32:47], v[92:95], v[116:119], v[32:47]
    v_rcp_f32 v51, v51
    v_rcp_f32 v52, v52
    v_rcp_f32 v53, v53
    v_mfma_f32_32x32x16_bf16 v[32:47], v[96:99], v[120:123], v[32:47]
    v_rcp_f32 v54, v54
    v_rcp_f32 v55, v55
    v_rcp_f32 v56, v56
    v_mfma_f32_32x32x16_bf16 v[32:47], v[100:103], v[124:127], v[32:47]
    v_rcp_f32 v57, v57
    v_rcp_f32 v58, v58
    v_rcp_f32 v59, v59
    v_rcp_f32 v60, v60
    v_rcp_f32 v61, v61
    v_rcp_f32 v62, v62
    v_rcp_f32 v63, v63
    v_pk_mul_f32 v[48:49], v[48:49], v[16:17]
    v_pk_mul_f32 v[50:51], v[50:51], v[18:19]
    v_pk_mul_f32 v[52:53], v[52:53], v[20:21]
    v_pk_mul_f32 v[54:55], v[54:55], v[22:23]
    v_pk_mul_f32 v[56:57], v[56:57], v[24:25]
    v_pk_mul_f32 v[58:59], v[58:59], v[26:27]
    v_pk_mul_f32 v[60:61], v[60:61], v[28:29]
    v_pk_mul_f32 v[62:63], v[62:63], v[30:31]
    v_cvt_pk_bf16_f32 v80, v48, v49
    v_cvt_pk_bf16_f32 v81, v50, v51
    v_cvt_pk_bf16_f32 v82, v52, v53
    v_cvt_pk_bf16_f32 v83, v54, v55
    v_cvt_pk_bf16_f32 v84, v56, v57
    v_cvt_pk_bf16_f32 v85, v58, v59
    v_cvt_pk_bf16_f32 v86, v60, v61
    v_cvt_pk_bf16_f32 v87, v62, v63
K2_T3A:
    s_waitcnt vmcnt(2) lgkmcnt(0)
    ds_read_b128 v[88:91], v2 offset:0
    ds_read_b128 v[92:95], v3 offset:0
    ds_read_b128 v[96:99], v4 offset:6144
    ds_read_b128 v[100:103], v5 offset:6144
    ds_read_b32 v8, v7 offset:768
    ds_read_b32 v14, v7 offset:832
    s_add_u32 m0, s53, 0
    s_setprio 3
    v_mfma_f32_32x32x16_bf16 v[64:79], v[80:83], v[104:107], v[64:79]
    v_exp_f32 v48, v32
    v_exp_f32 v49, v33
    v_exp_f32 v50, v34
    v_mfma_f32_32x32x16_bf16 v[64:79], v[84:87], v[108:111], v[64:79]
    v_exp_f32 v51, v35
    v_exp_f32 v52, v36
    v_exp_f32 v53, v37
    v_exp_f32 v54, v38
    v_exp_f32 v55, v39
    v_exp_f32 v56, v40
    v_exp_f32 v57, v41
    v_exp_f32 v58, v42
    v_exp_f32 v59, v43
    v_exp_f32 v60, v44
    v_exp_f32 v61, v45
    v_exp_f32 v62, v46
    v_exp_f32 v63, v47
    v_pk_add_f32 v[48:49], v[48:49], 1.0 op_sel_hi:[1,0]
    v_pk_add_f32 v[50:51], v[50:51], 1.0 op_sel_hi:[1,0]
    v_pk_add_f32 v[52:53], v[52:53], 1.0 op_sel_hi:[1,0]
    v_pk_add_f32 v[54:55], v[54:55], 1.0 op_sel_hi:[1,0]
    v_pk_add_f32 v[56:57], v[56:57], 1.0 op_sel_hi:[1,0]
    v_pk_add_f32 v[58:59], v[58:59], 1.0 op_sel_hi:[1,0]
    v_pk_add_f32 v[60:61], v[60:61], 1.0 op_sel_hi:[1,0]
    v_pk_add_f32 v[62:63], v[62:63], 1.0 op_sel_hi:[1,0]
    s_waitcnt lgkmcnt(0)
    buffer_load_dwordx4 v[8:9], s[68:71], 0 idxen offen lds
    s_add_u32 m0, s53, 1024
    ds_read_b64_tr_b16 v[104:105], v6 offset:4608
    buffer_load_dwordx4 v[14:15], s[68:71], 0 idxen offen lds
    ds_read_b64_tr_b16 v[106:107], v6 offset:4992
    ds_read_b64_tr_b16 v[108:109], v6 offset:5376
    ds_read_b64_tr_b16 v[110:111], v6 offset:5760
    v_mfma_f32_32x32x16_bf16 v[16:31], v[88:91], v[112:115], 0
    v_rcp_f32 v48, v48
    v_rcp_f32 v49, v49
    v_rcp_f32 v50, v50
    v_mfma_f32_32x32x16_bf16 v[16:31], v[92:95], v[116:119], v[16:31]
    v_rcp_f32 v51, v51
    v_rcp_f32 v52, v52
    v_rcp_f32 v53, v53
    v_mfma_f32_32x32x16_bf16 v[16:31], v[96:99], v[120:123], v[16:31]
    v_rcp_f32 v54, v54
    v_rcp_f32 v55, v55
    v_rcp_f32 v56, v56
    v_mfma_f32_32x32x16_bf16 v[16:31], v[100:103], v[124:127], v[16:31]
    v_rcp_f32 v57, v57
    v_rcp_f32 v58, v58
    v_rcp_f32 v59, v59
    v_rcp_f32 v60, v60
    v_rcp_f32 v61, v61
    v_rcp_f32 v62, v62
    v_rcp_f32 v63, v63
    v_pk_mul_f32 v[48:49], v[48:49], v[32:33]
    v_pk_mul_f32 v[50:51], v[50:51], v[34:35]
    v_pk_mul_f32 v[52:53], v[52:53], v[36:37]
    v_pk_mul_f32 v[54:55], v[54:55], v[38:39]
    v_pk_mul_f32 v[56:57], v[56:57], v[40:41]
    v_pk_mul_f32 v[58:59], v[58:59], v[42:43]
    v_pk_mul_f32 v[60:61], v[60:61], v[44:45]
    v_pk_mul_f32 v[62:63], v[62:63], v[46:47]
    v_cvt_pk_bf16_f32 v80, v48, v49
    v_cvt_pk_bf16_f32 v81, v50, v51
    v_cvt_pk_bf16_f32 v82, v52, v53
    v_cvt_pk_bf16_f32 v83, v54, v55
    v_cvt_pk_bf16_f32 v84, v56, v57
    v_cvt_pk_bf16_f32 v85, v58, v59
    v_cvt_pk_bf16_f32 v86, v60, v61
    v_cvt_pk_bf16_f32 v87, v62, v63
K2_T4A:
    s_waitcnt vmcnt(2) lgkmcnt(0)
    ds_read_b128 v[88:91], v2 offset:2048
    ds_read_b128 v[92:95], v3 offset:2048
    ds_read_b128 v[96:99], v4 offset:7680
    ds_read_b128 v[100:103], v5 offset:7680
    ds_read_b32 v8, v7 offset:896
    ds_read_b32 v14, v7 offset:960
    s_add_u32 m0, s53, 2048
    s_setprio 3
    v_mfma_f32_32x32x16_bf16 v[64:79], v[80:83], v[104:107], v[64:79]
    v_exp_f32 v48, v16
    v_exp_f32 v49, v17
    v_exp_f32 v50, v18
    v_mfma_f32_32x32x16_bf16 v[64:79], v[84:87], v[108:111], v[64:79]
    v_exp_f32 v51, v19
    v_exp_f32 v52, v20
    v_exp_f32 v53, v21
    v_exp_f32 v54, v22
    v_exp_f32 v55, v23
    v_exp_f32 v56, v24
    v_exp_f32 v57, v25
    v_exp_f32 v58, v26
    v_exp_f32 v59, v27
    v_exp_f32 v60, v28
    v_exp_f32 v61, v29
    v_exp_f32 v62, v30
    v_exp_f32 v63, v31
    v_pk_add_f32 v[48:49], v[48:49], 1.0 op_sel_hi:[1,0]
    v_pk_add_f32 v[50:51], v[50:51], 1.0 op_sel_hi:[1,0]
    v_pk_add_f32 v[52:53], v[52:53], 1.0 op_sel_hi:[1,0]
    v_pk_add_f32 v[54:55], v[54:55], 1.0 op_sel_hi:[1,0]
    v_pk_add_f32 v[56:57], v[56:57], 1.0 op_sel_hi:[1,0]
    v_pk_add_f32 v[58:59], v[58:59], 1.0 op_sel_hi:[1,0]
    v_pk_add_f32 v[60:61], v[60:61], 1.0 op_sel_hi:[1,0]
    v_pk_add_f32 v[62:63], v[62:63], 1.0 op_sel_hi:[1,0]
    s_waitcnt lgkmcnt(0)
    buffer_load_dwordx4 v[8:9], s[68:71], 0 idxen offen lds
    s_add_u32 m0, s53, 3072
    ds_read_b64_tr_b16 v[104:105], v6 offset:6144
    buffer_load_dwordx4 v[14:15], s[68:71], 0 idxen offen lds
    ds_read_b64_tr_b16 v[106:107], v6 offset:6528
    ds_read_b64_tr_b16 v[108:109], v6 offset:6912
    ds_read_b64_tr_b16 v[110:111], v6 offset:7296
    v_mfma_f32_32x32x16_bf16 v[32:47], v[88:91], v[112:115], 0
    v_rcp_f32 v48, v48
    v_rcp_f32 v49, v49
    v_rcp_f32 v50, v50
    v_mfma_f32_32x32x16_bf16 v[32:47], v[92:95], v[116:119], v[32:47]
    v_rcp_f32 v51, v51
    v_rcp_f32 v52, v52
    v_rcp_f32 v53, v53
    v_mfma_f32_32x32x16_bf16 v[32:47], v[96:99], v[120:123], v[32:47]
    v_rcp_f32 v54, v54
    v_rcp_f32 v55, v55
    v_rcp_f32 v56, v56
    v_mfma_f32_32x32x16_bf16 v[32:47], v[100:103], v[124:127], v[32:47]
    v_rcp_f32 v57, v57
    v_rcp_f32 v58, v58
    v_rcp_f32 v59, v59
    v_rcp_f32 v60, v60
    v_rcp_f32 v61, v61
    v_rcp_f32 v62, v62
    v_rcp_f32 v63, v63
    v_pk_mul_f32 v[48:49], v[48:49], v[16:17]
    v_pk_mul_f32 v[50:51], v[50:51], v[18:19]
    v_pk_mul_f32 v[52:53], v[52:53], v[20:21]
    v_pk_mul_f32 v[54:55], v[54:55], v[22:23]
    v_pk_mul_f32 v[56:57], v[56:57], v[24:25]
    v_pk_mul_f32 v[58:59], v[58:59], v[26:27]
    v_pk_mul_f32 v[60:61], v[60:61], v[28:29]
    v_pk_mul_f32 v[62:63], v[62:63], v[30:31]
    v_cvt_pk_bf16_f32 v80, v48, v49
    v_cvt_pk_bf16_f32 v81, v50, v51
    v_cvt_pk_bf16_f32 v82, v52, v53
    v_cvt_pk_bf16_f32 v83, v54, v55
    v_cvt_pk_bf16_f32 v84, v56, v57
    v_cvt_pk_bf16_f32 v85, v58, v59
    v_cvt_pk_bf16_f32 v86, v60, v61
    v_cvt_pk_bf16_f32 v87, v62, v63
K2_T5A:
    s_waitcnt vmcnt(2) lgkmcnt(0)
    ds_read_b128 v[88:91], v2 offset:0
    ds_read_b128 v[92:95], v3 offset:0
    ds_read_b128 v[96:99], v4 offset:9216
    ds_read_b128 v[100:103], v5 offset:9216
    ds_read_b32 v8, v7 offset:1024
    ds_read_b32 v14, v7 offset:1088
    s_add_u32 m0, s53, 0
    s_setprio 3
    v_mfma_f32_32x32x16_bf16 v[64:79], v[80:83], v[104:107], v[64:79]
    v_exp_f32 v48, v32
    v_exp_f32 v49, v33
    v_exp_f32 v50, v34
    v_mfma_f32_32x32x16_bf16 v[64:79], v[84:87], v[108:111], v[64:79]
    v_exp_f32 v51, v35
    v_exp_f32 v52, v36
    v_exp_f32 v53, v37
    v_exp_f32 v54, v38
    v_exp_f32 v55, v39
    v_exp_f32 v56, v40
    v_exp_f32 v57, v41
    v_exp_f32 v58, v42
    v_exp_f32 v59, v43
    v_exp_f32 v60, v44
    v_exp_f32 v61, v45
    v_exp_f32 v62, v46
    v_exp_f32 v63, v47
    v_pk_add_f32 v[48:49], v[48:49], 1.0 op_sel_hi:[1,0]
    v_pk_add_f32 v[50:51], v[50:51], 1.0 op_sel_hi:[1,0]
    v_pk_add_f32 v[52:53], v[52:53], 1.0 op_sel_hi:[1,0]
    v_pk_add_f32 v[54:55], v[54:55], 1.0 op_sel_hi:[1,0]
    v_pk_add_f32 v[56:57], v[56:57], 1.0 op_sel_hi:[1,0]
    v_pk_add_f32 v[58:59], v[58:59], 1.0 op_sel_hi:[1,0]
    v_pk_add_f32 v[60:61], v[60:61], 1.0 op_sel_hi:[1,0]
    v_pk_add_f32 v[62:63], v[62:63], 1.0 op_sel_hi:[1,0]
    s_waitcnt lgkmcnt(0)
    buffer_load_dwordx4 v[8:9], s[68:71], 0 idxen offen lds
    s_add_u32 m0, s53, 1024
    ds_read_b64_tr_b16 v[104:105], v6 offset:7680
    buffer_load_dwordx4 v[14:15], s[68:71], 0 idxen offen lds
    ds_read_b64_tr_b16 v[106:107], v6 offset:8064
    ds_read_b64_tr_b16 v[108:109], v6 offset:8448
    ds_read_b64_tr_b16 v[110:111], v6 offset:8832
    v_mfma_f32_32x32x16_bf16 v[16:31], v[88:91], v[112:115], 0
    v_rcp_f32 v48, v48
    v_rcp_f32 v49, v49
    v_rcp_f32 v50, v50
    v_mfma_f32_32x32x16_bf16 v[16:31], v[92:95], v[116:119], v[16:31]
    v_rcp_f32 v51, v51
    v_rcp_f32 v52, v52
    v_rcp_f32 v53, v53
    v_mfma_f32_32x32x16_bf16 v[16:31], v[96:99], v[120:123], v[16:31]
    v_rcp_f32 v54, v54
    v_rcp_f32 v55, v55
    v_rcp_f32 v56, v56
    v_mfma_f32_32x32x16_bf16 v[16:31], v[100:103], v[124:127], v[16:31]
    v_rcp_f32 v57, v57
    v_rcp_f32 v58, v58
    v_rcp_f32 v59, v59
    v_rcp_f32 v60, v60
    v_rcp_f32 v61, v61
    v_rcp_f32 v62, v62
    v_rcp_f32 v63, v63
    v_pk_mul_f32 v[48:49], v[48:49], v[32:33]
    v_pk_mul_f32 v[50:51], v[50:51], v[34:35]
    v_pk_mul_f32 v[52:53], v[52:53], v[36:37]
    v_pk_mul_f32 v[54:55], v[54:55], v[38:39]
    v_pk_mul_f32 v[56:57], v[56:57], v[40:41]
    v_pk_mul_f32 v[58:59], v[58:59], v[42:43]
    v_pk_mul_f32 v[60:61], v[60:61], v[44:45]
    v_pk_mul_f32 v[62:63], v[62:63], v[46:47]
    v_cvt_pk_bf16_f32 v80, v48, v49
    v_cvt_pk_bf16_f32 v81, v50, v51
    v_cvt_pk_bf16_f32 v82, v52, v53
    v_cvt_pk_bf16_f32 v83, v54, v55
    v_cvt_pk_bf16_f32 v84, v56, v57
    v_cvt_pk_bf16_f32 v85, v58, v59
    v_cvt_pk_bf16_f32 v86, v60, v61
    v_cvt_pk_bf16_f32 v87, v62, v63
K2_T6A:
    s_waitcnt vmcnt(2) lgkmcnt(0)
    ds_read_b128 v[88:91], v2 offset:2048
    ds_read_b128 v[92:95], v3 offset:2048
    ds_read_b128 v[96:99], v4 offset:10752
    ds_read_b128 v[100:103], v5 offset:10752
    ds_read_b32 v8, v7 offset:1152
    ds_read_b32 v14, v7 offset:1216
    s_add_u32 m0, s53, 2048
    s_setprio 2
    v_mfma_f32_32x32x16_bf16 v[64:79], v[80:83], v[104:107], v[64:79]
    v_exp_f32 v48, v16
    v_exp_f32 v49, v17
    v_exp_f32 v50, v18
    v_mfma_f32_32x32x16_bf16 v[64:79], v[84:87], v[108:111], v[64:79]
    v_exp_f32 v51, v19
    v_exp_f32 v52, v20
    v_exp_f32 v53, v21
    v_exp_f32 v54, v22
    v_exp_f32 v55, v23
    v_exp_f32 v56, v24
    v_exp_f32 v57, v25
    v_exp_f32 v58, v26
    v_exp_f32 v59, v27
    v_exp_f32 v60, v28
    v_exp_f32 v61, v29
    v_exp_f32 v62, v30
    v_exp_f32 v63, v31
    v_pk_add_f32 v[48:49], v[48:49], 1.0 op_sel_hi:[1,0]
    v_pk_add_f32 v[50:51], v[50:51], 1.0 op_sel_hi:[1,0]
    v_pk_add_f32 v[52:53], v[52:53], 1.0 op_sel_hi:[1,0]
    v_pk_add_f32 v[54:55], v[54:55], 1.0 op_sel_hi:[1,0]
    v_pk_add_f32 v[56:57], v[56:57], 1.0 op_sel_hi:[1,0]
    v_pk_add_f32 v[58:59], v[58:59], 1.0 op_sel_hi:[1,0]
    v_pk_add_f32 v[60:61], v[60:61], 1.0 op_sel_hi:[1,0]
    v_pk_add_f32 v[62:63], v[62:63], 1.0 op_sel_hi:[1,0]
    s_waitcnt lgkmcnt(0)
    buffer_load_dwordx4 v[8:9], s[68:71], 0 idxen offen lds
    s_add_u32 m0, s53, 3072
    ds_read_b64_tr_b16 v[104:105], v6 offset:9216
    buffer_load_dwordx4 v[14:15], s[68:71], 0 idxen offen lds
    ds_read_b64_tr_b16 v[106:107], v6 offset:9600
    ds_read_b64_tr_b16 v[108:109], v6 offset:9984
    ds_read_b64_tr_b16 v[110:111], v6 offset:10368
    v_mfma_f32_32x32x16_bf16 v[32:47], v[88:91], v[112:115], 0
    v_rcp_f32 v48, v48
    v_rcp_f32 v49, v49
    v_rcp_f32 v50, v50
    v_mfma_f32_32x32x16_bf16 v[32:47], v[92:95], v[116:119], v[32:47]
    v_rcp_f32 v51, v51
    v_rcp_f32 v52, v52
    v_rcp_f32 v53, v53
    v_mfma_f32_32x32x16_bf16 v[32:47], v[96:99], v[120:123], v[32:47]
    v_rcp_f32 v54, v54
    v_rcp_f32 v55, v55
    v_rcp_f32 v56, v56
    v_mfma_f32_32x32x16_bf16 v[32:47], v[100:103], v[124:127], v[32:47]
    v_rcp_f32 v57, v57
    v_rcp_f32 v58, v58
    v_rcp_f32 v59, v59
    v_rcp_f32 v60, v60
    v_rcp_f32 v61, v61
    v_rcp_f32 v62, v62
    v_rcp_f32 v63, v63
    v_pk_mul_f32 v[48:49], v[48:49], v[16:17]
    v_pk_mul_f32 v[50:51], v[50:51], v[18:19]
    v_pk_mul_f32 v[52:53], v[52:53], v[20:21]
    v_pk_mul_f32 v[54:55], v[54:55], v[22:23]
    v_pk_mul_f32 v[56:57], v[56:57], v[24:25]
    v_pk_mul_f32 v[58:59], v[58:59], v[26:27]
    v_pk_mul_f32 v[60:61], v[60:61], v[28:29]
    v_pk_mul_f32 v[62:63], v[62:63], v[30:31]
    v_cvt_pk_bf16_f32 v80, v48, v49
    v_cvt_pk_bf16_f32 v81, v50, v51
    v_cvt_pk_bf16_f32 v82, v52, v53
    v_cvt_pk_bf16_f32 v83, v54, v55
    v_cvt_pk_bf16_f32 v84, v56, v57
    v_cvt_pk_bf16_f32 v85, v58, v59
    v_cvt_pk_bf16_f32 v86, v60, v61
    v_cvt_pk_bf16_f32 v87, v62, v63
K2_T7A:
    s_waitcnt vmcnt(2) lgkmcnt(0)
    ds_read_b128 v[88:91], v2 offset:0
    ds_read_b128 v[92:95], v3 offset:0
    ds_read_b128 v[96:99], v4 offset:12288
    ds_read_b128 v[100:103], v5 offset:12288
    ds_read_b32 v8, v7 offset:1280
    ds_read_b32 v14, v7 offset:1344
    s_add_u32 m0, s53, 0
    s_setprio 2
    v_mfma_f32_32x32x16_bf16 v[64:79], v[80:83], v[104:107], v[64:79]
    v_exp_f32 v48, v32
    v_exp_f32 v49, v33
    v_exp_f32 v50, v34
    v_mfma_f32_32x32x16_bf16 v[64:79], v[84:87], v[108:111], v[64:79]
    v_exp_f32 v51, v35
    v_exp_f32 v52, v36
    v_exp_f32 v53, v37
    v_exp_f32 v54, v38
    v_exp_f32 v55, v39
    v_exp_f32 v56, v40
    v_exp_f32 v57, v41
    v_exp_f32 v58, v42
    v_exp_f32 v59, v43
    v_exp_f32 v60, v44
    v_exp_f32 v61, v45
    v_exp_f32 v62, v46
    v_exp_f32 v63, v47
    v_pk_add_f32 v[48:49], v[48:49], 1.0 op_sel_hi:[1,0]
    v_pk_add_f32 v[50:51], v[50:51], 1.0 op_sel_hi:[1,0]
    v_pk_add_f32 v[52:53], v[52:53], 1.0 op_sel_hi:[1,0]
    v_pk_add_f32 v[54:55], v[54:55], 1.0 op_sel_hi:[1,0]
    v_pk_add_f32 v[56:57], v[56:57], 1.0 op_sel_hi:[1,0]
    v_pk_add_f32 v[58:59], v[58:59], 1.0 op_sel_hi:[1,0]
    v_pk_add_f32 v[60:61], v[60:61], 1.0 op_sel_hi:[1,0]
    v_pk_add_f32 v[62:63], v[62:63], 1.0 op_sel_hi:[1,0]
    s_waitcnt lgkmcnt(0)
    buffer_load_dwordx4 v[8:9], s[68:71], 0 idxen offen lds
    s_add_u32 m0, s53, 1024
    ds_read_b64_tr_b16 v[104:105], v6 offset:10752
    buffer_load_dwordx4 v[14:15], s[68:71], 0 idxen offen lds
    ds_read_b64_tr_b16 v[106:107], v6 offset:11136
    ds_read_b64_tr_b16 v[108:109], v6 offset:11520
    ds_read_b64_tr_b16 v[110:111], v6 offset:11904
    v_mfma_f32_32x32x16_bf16 v[16:31], v[88:91], v[112:115], 0
    v_rcp_f32 v48, v48
    v_rcp_f32 v49, v49
    v_rcp_f32 v50, v50
    v_mfma_f32_32x32x16_bf16 v[16:31], v[92:95], v[116:119], v[16:31]
    v_rcp_f32 v51, v51
    v_rcp_f32 v52, v52
    v_rcp_f32 v53, v53
    v_mfma_f32_32x32x16_bf16 v[16:31], v[96:99], v[120:123], v[16:31]
    v_rcp_f32 v54, v54
    v_rcp_f32 v55, v55
    v_rcp_f32 v56, v56
    v_mfma_f32_32x32x16_bf16 v[16:31], v[100:103], v[124:127], v[16:31]
    v_rcp_f32 v57, v57
    v_rcp_f32 v58, v58
    v_rcp_f32 v59, v59
    v_rcp_f32 v60, v60
    v_rcp_f32 v61, v61
    v_rcp_f32 v62, v62
    v_rcp_f32 v63, v63
    v_pk_mul_f32 v[48:49], v[48:49], v[32:33]
    v_pk_mul_f32 v[50:51], v[50:51], v[34:35]
    v_pk_mul_f32 v[52:53], v[52:53], v[36:37]
    v_pk_mul_f32 v[54:55], v[54:55], v[38:39]
    v_pk_mul_f32 v[56:57], v[56:57], v[40:41]
    v_pk_mul_f32 v[58:59], v[58:59], v[42:43]
    v_pk_mul_f32 v[60:61], v[60:61], v[44:45]
    v_pk_mul_f32 v[62:63], v[62:63], v[46:47]
    v_cvt_pk_bf16_f32 v80, v48, v49
    v_cvt_pk_bf16_f32 v81, v50, v51
    v_cvt_pk_bf16_f32 v82, v52, v53
    v_cvt_pk_bf16_f32 v83, v54, v55
    v_cvt_pk_bf16_f32 v84, v56, v57
    v_cvt_pk_bf16_f32 v85, v58, v59
    v_cvt_pk_bf16_f32 v86, v60, v61
    v_cvt_pk_bf16_f32 v87, v62, v63
K2_T8A:
    s_waitcnt vmcnt(2) lgkmcnt(0)
    ds_read_b128 v[88:91], v2 offset:2048
    ds_read_b128 v[92:95], v3 offset:2048
    ds_read_b128 v[96:99], v4 offset:13824
    ds_read_b128 v[100:103], v5 offset:13824
    ds_read_b32 v8, v7 offset:1408
    ds_read_b32 v14, v7 offset:1472
    s_add_u32 m0, s53, 2048
    s_setprio 2
    v_mfma_f32_32x32x16_bf16 v[64:79], v[80:83], v[104:107], v[64:79]
    v_exp_f32 v48, v16
    v_exp_f32 v49, v17
    v_exp_f32 v50, v18
    v_mfma_f32_32x32x16_bf16 v[64:79], v[84:87], v[108:111], v[64:79]
    v_exp_f32 v51, v19
    v_exp_f32 v52, v20
    v_exp_f32 v53, v21
    v_exp_f32 v54, v22
    v_exp_f32 v55, v23
    v_exp_f32 v56, v24
    v_exp_f32 v57, v25
    v_exp_f32 v58, v26
    v_exp_f32 v59, v27
    v_exp_f32 v60, v28
    v_exp_f32 v61, v29
    v_exp_f32 v62, v30
    v_exp_f32 v63, v31
    v_pk_add_f32 v[48:49], v[48:49], 1.0 op_sel_hi:[1,0]
    v_pk_add_f32 v[50:51], v[50:51], 1.0 op_sel_hi:[1,0]
    v_pk_add_f32 v[52:53], v[52:53], 1.0 op_sel_hi:[1,0]
    v_pk_add_f32 v[54:55], v[54:55], 1.0 op_sel_hi:[1,0]
    v_pk_add_f32 v[56:57], v[56:57], 1.0 op_sel_hi:[1,0]
    v_pk_add_f32 v[58:59], v[58:59], 1.0 op_sel_hi:[1,0]
    v_pk_add_f32 v[60:61], v[60:61], 1.0 op_sel_hi:[1,0]
    v_pk_add_f32 v[62:63], v[62:63], 1.0 op_sel_hi:[1,0]
    s_waitcnt lgkmcnt(0)
    buffer_load_dwordx4 v[8:9], s[68:71], 0 idxen offen lds
    s_add_u32 m0, s53, 3072
    ds_read_b64_tr_b16 v[104:105], v6 offset:12288
    buffer_load_dwordx4 v[14:15], s[68:71], 0 idxen offen lds
    ds_read_b64_tr_b16 v[106:107], v6 offset:12672
    ds_read_b64_tr_b16 v[108:109], v6 offset:13056
    ds_read_b64_tr_b16 v[110:111], v6 offset:13440
    v_mfma_f32_32x32x16_bf16 v[32:47], v[88:91], v[112:115], 0
    v_rcp_f32 v48, v48
    v_rcp_f32 v49, v49
    v_rcp_f32 v50, v50
    v_mfma_f32_32x32x16_bf16 v[32:47], v[92:95], v[116:119], v[32:47]
    v_rcp_f32 v51, v51
    v_rcp_f32 v52, v52
    v_rcp_f32 v53, v53
    v_mfma_f32_32x32x16_bf16 v[32:47], v[96:99], v[120:123], v[32:47]
    v_rcp_f32 v54, v54
    v_rcp_f32 v55, v55
    v_rcp_f32 v56, v56
    v_mfma_f32_32x32x16_bf16 v[32:47], v[100:103], v[124:127], v[32:47]
    v_rcp_f32 v57, v57
    v_rcp_f32 v58, v58
    v_rcp_f32 v59, v59
    v_rcp_f32 v60, v60
    v_rcp_f32 v61, v61
    v_rcp_f32 v62, v62
    v_rcp_f32 v63, v63
    v_pk_mul_f32 v[48:49], v[48:49], v[16:17]
    v_pk_mul_f32 v[50:51], v[50:51], v[18:19]
    v_pk_mul_f32 v[52:53], v[52:53], v[20:21]
    v_pk_mul_f32 v[54:55], v[54:55], v[22:23]
    v_pk_mul_f32 v[56:57], v[56:57], v[24:25]
    v_pk_mul_f32 v[58:59], v[58:59], v[26:27]
    v_pk_mul_f32 v[60:61], v[60:61], v[28:29]
    v_pk_mul_f32 v[62:63], v[62:63], v[30:31]
    v_cvt_pk_bf16_f32 v80, v48, v49
    v_cvt_pk_bf16_f32 v81, v50, v51
    v_cvt_pk_bf16_f32 v82, v52, v53
    v_cvt_pk_bf16_f32 v83, v54, v55
    v_cvt_pk_bf16_f32 v84, v56, v57
    v_cvt_pk_bf16_f32 v85, v58, v59
    v_cvt_pk_bf16_f32 v86, v60, v61
    v_cvt_pk_bf16_f32 v87, v62, v63
K2_T9A:
    s_waitcnt vmcnt(2) lgkmcnt(0)
    ds_read_b128 v[88:91], v2 offset:0
    ds_read_b128 v[92:95], v3 offset:0
    ds_read_b128 v[96:99], v4 offset:15360
    ds_read_b128 v[100:103], v5 offset:15360
    ds_read_b32 v8, v7 offset:1536
    ds_read_b32 v14, v7 offset:1600
    s_add_u32 m0, s53, 0
    s_setprio 2
    v_mfma_f32_32x32x16_bf16 v[64:79], v[80:83], v[104:107], v[64:79]
    v_exp_f32 v48, v32
    v_exp_f32 v49, v33
    v_exp_f32 v50, v34
    v_mfma_f32_32x32x16_bf16 v[64:79], v[84:87], v[108:111], v[64:79]
    v_exp_f32 v51, v35
    v_exp_f32 v52, v36
    v_exp_f32 v53, v37
    v_exp_f32 v54, v38
    v_exp_f32 v55, v39
    v_exp_f32 v56, v40
    v_exp_f32 v57, v41
    v_exp_f32 v58, v42
    v_exp_f32 v59, v43
    v_exp_f32 v60, v44
    v_exp_f32 v61, v45
    v_exp_f32 v62, v46
    v_exp_f32 v63, v47
    v_pk_add_f32 v[48:49], v[48:49], 1.0 op_sel_hi:[1,0]
    v_pk_add_f32 v[50:51], v[50:51], 1.0 op_sel_hi:[1,0]
    v_pk_add_f32 v[52:53], v[52:53], 1.0 op_sel_hi:[1,0]
    v_pk_add_f32 v[54:55], v[54:55], 1.0 op_sel_hi:[1,0]
    v_pk_add_f32 v[56:57], v[56:57], 1.0 op_sel_hi:[1,0]
    v_pk_add_f32 v[58:59], v[58:59], 1.0 op_sel_hi:[1,0]
    v_pk_add_f32 v[60:61], v[60:61], 1.0 op_sel_hi:[1,0]
    v_pk_add_f32 v[62:63], v[62:63], 1.0 op_sel_hi:[1,0]
    s_waitcnt lgkmcnt(0)
    buffer_load_dwordx4 v[8:9], s[68:71], 0 idxen offen lds
    s_add_u32 m0, s53, 1024
    ds_read_b64_tr_b16 v[104:105], v6 offset:13824
    buffer_load_dwordx4 v[14:15], s[68:71], 0 idxen offen lds
    ds_read_b64_tr_b16 v[106:107], v6 offset:14208
    ds_read_b64_tr_b16 v[108:109], v6 offset:14592
    ds_read_b64_tr_b16 v[110:111], v6 offset:14976
    v_mfma_f32_32x32x16_bf16 v[16:31], v[88:91], v[112:115], 0
    v_rcp_f32 v48, v48
    v_rcp_f32 v49, v49
    v_rcp_f32 v50, v50
    v_mfma_f32_32x32x16_bf16 v[16:31], v[92:95], v[116:119], v[16:31]
    v_rcp_f32 v51, v51
    v_rcp_f32 v52, v52
    v_rcp_f32 v53, v53
    v_mfma_f32_32x32x16_bf16 v[16:31], v[96:99], v[120:123], v[16:31]
    v_rcp_f32 v54, v54
    v_rcp_f32 v55, v55
    v_rcp_f32 v56, v56
    v_mfma_f32_32x32x16_bf16 v[16:31], v[100:103], v[124:127], v[16:31]
    v_rcp_f32 v57, v57
    v_rcp_f32 v58, v58
    v_rcp_f32 v59, v59
    v_rcp_f32 v60, v60
    v_rcp_f32 v61, v61
    v_rcp_f32 v62, v62
    v_rcp_f32 v63, v63
    v_pk_mul_f32 v[48:49], v[48:49], v[32:33]
    v_pk_mul_f32 v[50:51], v[50:51], v[34:35]
    v_pk_mul_f32 v[52:53], v[52:53], v[36:37]
    v_pk_mul_f32 v[54:55], v[54:55], v[38:39]
    v_pk_mul_f32 v[56:57], v[56:57], v[40:41]
    v_pk_mul_f32 v[58:59], v[58:59], v[42:43]
    v_pk_mul_f32 v[60:61], v[60:61], v[44:45]
    v_pk_mul_f32 v[62:63], v[62:63], v[46:47]
    v_cvt_pk_bf16_f32 v80, v48, v49
    v_cvt_pk_bf16_f32 v81, v50, v51
    v_cvt_pk_bf16_f32 v82, v52, v53
    v_cvt_pk_bf16_f32 v83, v54, v55
    v_cvt_pk_bf16_f32 v84, v56, v57
    v_cvt_pk_bf16_f32 v85, v58, v59
    v_cvt_pk_bf16_f32 v86, v60, v61
    v_cvt_pk_bf16_f32 v87, v62, v63
K2_T10A:
    s_waitcnt vmcnt(2) lgkmcnt(0)
    ds_read_b128 v[88:91], v2 offset:2048
    ds_read_b128 v[92:95], v3 offset:2048
    ds_read_b128 v[96:99], v4 offset:16896
    ds_read_b128 v[100:103], v5 offset:16896
    s_setprio 1
    v_mfma_f32_32x32x16_bf16 v[64:79], v[80:83], v[104:107], v[64:79]
    v_exp_f32 v48, v16
    v_exp_f32 v49, v17
    v_exp_f32 v50, v18
    v_mfma_f32_32x32x16_bf16 v[64:79], v[84:87], v[108:111], v[64:79]
    v_exp_f32 v51, v19
    v_exp_f32 v52, v20
    v_exp_f32 v53, v21
    v_exp_f32 v54, v22
    v_exp_f32 v55, v23
    v_exp_f32 v56, v24
    v_exp_f32 v57, v25
    v_exp_f32 v58, v26
    v_exp_f32 v59, v27
    v_exp_f32 v60, v28
    v_exp_f32 v61, v29
    v_exp_f32 v62, v30
    v_exp_f32 v63, v31
    v_pk_add_f32 v[48:49], v[48:49], 1.0 op_sel_hi:[1,0]
    v_pk_add_f32 v[50:51], v[50:51], 1.0 op_sel_hi:[1,0]
    v_pk_add_f32 v[52:53], v[52:53], 1.0 op_sel_hi:[1,0]
    v_pk_add_f32 v[54:55], v[54:55], 1.0 op_sel_hi:[1,0]
    v_pk_add_f32 v[56:57], v[56:57], 1.0 op_sel_hi:[1,0]
    v_pk_add_f32 v[58:59], v[58:59], 1.0 op_sel_hi:[1,0]
    v_pk_add_f32 v[60:61], v[60:61], 1.0 op_sel_hi:[1,0]
    v_pk_add_f32 v[62:63], v[62:63], 1.0 op_sel_hi:[1,0]
    s_waitcnt lgkmcnt(0)
    ds_read_b64_tr_b16 v[104:105], v6 offset:15360
    ds_read_b64_tr_b16 v[106:107], v6 offset:15744
    ds_read_b64_tr_b16 v[108:109], v6 offset:16128
    ds_read_b64_tr_b16 v[110:111], v6 offset:16512
    buffer_load_dwordx4 v[160:163], v12, s[32:35], s26 offen offset:0
    buffer_load_dwordx4 v[164:167], v12, s[32:35], s26 offen offset:1024
    buffer_load_dwordx4 v[168:171], v12, s[32:35], s28 offen offset:0
    buffer_load_dwordx4 v[172:175], v12, s[32:35], s28 offen offset:1024
    buffer_load_dwordx4 v[176:179], v12, s[32:35], s30 offen offset:0
    buffer_load_dwordx4 v[180:183], v12, s[32:35], s30 offen offset:1024
    buffer_load_dwordx4 v[184:187], v12, s[32:35], s66 offen offset:0
    buffer_load_dwordx4 v[188:191], v12, s[32:35], s66 offen offset:1024
    buffer_load_dwordx4 v[144:147], v152, s[36:39], s5 offen
    buffer_load_dwordx4 v[148:151], v152, s[36:39], s5 offen offset:32
    v_mfma_f32_32x32x16_bf16 v[32:47], v[88:91], v[112:115], 0
    v_rcp_f32 v48, v48
    v_rcp_f32 v49, v49
    v_rcp_f32 v50, v50
    v_mfma_f32_32x32x16_bf16 v[32:47], v[92:95], v[116:119], v[32:47]
    v_rcp_f32 v51, v51
    v_rcp_f32 v52, v52
    v_rcp_f32 v53, v53
    v_mfma_f32_32x32x16_bf16 v[32:47], v[96:99], v[120:123], v[32:47]
    v_rcp_f32 v54, v54
    v_rcp_f32 v55, v55
    v_rcp_f32 v56, v56
    v_mfma_f32_32x32x16_bf16 v[32:47], v[100:103], v[124:127], v[32:47]
    v_rcp_f32 v57, v57
    v_rcp_f32 v58, v58
    v_rcp_f32 v59, v59
    v_rcp_f32 v60, v60
    v_rcp_f32 v61, v61
    v_rcp_f32 v62, v62
    v_rcp_f32 v63, v63
    v_pk_mul_f32 v[48:49], v[48:49], v[16:17]
    v_pk_mul_f32 v[50:51], v[50:51], v[18:19]
    v_pk_mul_f32 v[52:53], v[52:53], v[20:21]
    v_pk_mul_f32 v[54:55], v[54:55], v[22:23]
    v_pk_mul_f32 v[56:57], v[56:57], v[24:25]
    v_pk_mul_f32 v[58:59], v[58:59], v[26:27]
    v_pk_mul_f32 v[60:61], v[60:61], v[28:29]
    v_pk_mul_f32 v[62:63], v[62:63], v[30:31]
    v_cvt_pk_bf16_f32 v80, v48, v49
    v_cvt_pk_bf16_f32 v81, v50, v51
    v_cvt_pk_bf16_f32 v82, v52, v53
    v_cvt_pk_bf16_f32 v83, v54, v55
    v_cvt_pk_bf16_f32 v84, v56, v57
    v_cvt_pk_bf16_f32 v85, v58, v59
    v_cvt_pk_bf16_f32 v86, v60, v61
    v_cvt_pk_bf16_f32 v87, v62, v63
K2_T11A:
    s_waitcnt vmcnt(10) lgkmcnt(0)
    ds_read_b128 v[88:91], v2 offset:0
    ds_read_b128 v[92:95], v3 offset:0
    ds_read_b128 v[96:99], v4 offset:18432
    ds_read_b128 v[100:103], v5 offset:18432
    s_setprio 1
    v_mfma_f32_32x32x16_bf16 v[64:79], v[80:83], v[104:107], v[64:79]
    v_exp_f32 v48, v32
    v_exp_f32 v49, v33
    v_exp_f32 v50, v34
    v_mfma_f32_32x32x16_bf16 v[64:79], v[84:87], v[108:111], v[64:79]
    v_exp_f32 v51, v35
    v_exp_f32 v52, v36
    v_exp_f32 v53, v37
    v_exp_f32 v54, v38
    v_exp_f32 v55, v39
    v_exp_f32 v56, v40
    v_exp_f32 v57, v41
    v_exp_f32 v58, v42
    v_exp_f32 v59, v43
    v_exp_f32 v60, v44
    v_exp_f32 v61, v45
    v_exp_f32 v62, v46
    v_exp_f32 v63, v47
    v_pk_add_f32 v[48:49], v[48:49], 1.0 op_sel_hi:[1,0]
    v_pk_add_f32 v[50:51], v[50:51], 1.0 op_sel_hi:[1,0]
    v_pk_add_f32 v[52:53], v[52:53], 1.0 op_sel_hi:[1,0]
    v_pk_add_f32 v[54:55], v[54:55], 1.0 op_sel_hi:[1,0]
    v_pk_add_f32 v[56:57], v[56:57], 1.0 op_sel_hi:[1,0]
    v_pk_add_f32 v[58:59], v[58:59], 1.0 op_sel_hi:[1,0]
    v_pk_add_f32 v[60:61], v[60:61], 1.0 op_sel_hi:[1,0]
    v_pk_add_f32 v[62:63], v[62:63], 1.0 op_sel_hi:[1,0]
    s_waitcnt lgkmcnt(0)
    ds_read_b64_tr_b16 v[104:105], v6 offset:16896
    ds_read_b64_tr_b16 v[106:107], v6 offset:17280
    ds_read_b64_tr_b16 v[108:109], v6 offset:17664
    ds_read_b64_tr_b16 v[110:111], v6 offset:18048
    v_mfma_f32_32x32x16_bf16 v[16:31], v[88:91], v[112:115], 0
    v_rcp_f32 v48, v48
    v_rcp_f32 v49, v49
    v_rcp_f32 v50, v50
    v_mfma_f32_32x32x16_bf16 v[16:31], v[92:95], v[116:119], v[16:31]
    v_rcp_f32 v51, v51
    v_rcp_f32 v52, v52
    v_rcp_f32 v53, v53
    v_mfma_f32_32x32x16_bf16 v[16:31], v[96:99], v[120:123], v[16:31]
    v_rcp_f32 v54, v54
    v_rcp_f32 v55, v55
    v_rcp_f32 v56, v56
    v_mfma_f32_32x32x16_bf16 v[16:31], v[100:103], v[124:127], v[16:31]
    v_rcp_f32 v57, v57
    v_rcp_f32 v58, v58
    v_rcp_f32 v59, v59
    v_rcp_f32 v60, v60
    v_rcp_f32 v61, v61
    v_rcp_f32 v62, v62
    v_rcp_f32 v63, v63
    v_pk_mul_f32 v[48:49], v[48:49], v[32:33]
    v_pk_mul_f32 v[50:51], v[50:51], v[34:35]
    v_pk_mul_f32 v[52:53], v[52:53], v[36:37]
    v_pk_mul_f32 v[54:55], v[54:55], v[38:39]
    v_pk_mul_f32 v[56:57], v[56:57], v[40:41]
    v_pk_mul_f32 v[58:59], v[58:59], v[42:43]
    v_pk_mul_f32 v[60:61], v[60:61], v[44:45]
    v_pk_mul_f32 v[62:63], v[62:63], v[46:47]
    v_cvt_pk_bf16_f32 v80, v48, v49
    v_cvt_pk_bf16_f32 v81, v50, v51
    v_cvt_pk_bf16_f32 v82, v52, v53
    v_cvt_pk_bf16_f32 v83, v54, v55
    v_cvt_pk_bf16_f32 v84, v56, v57
    v_cvt_pk_bf16_f32 v85, v58, v59
    v_cvt_pk_bf16_f32 v86, v60, v61
    v_cvt_pk_bf16_f32 v87, v62, v63
K2_T12A:
    s_cmp_lg_u32 s50, 0
    s_cbranch_scc1 K2_THA
    s_waitcnt lgkmcnt(0)
    s_setprio 0
    v_mfma_f32_32x32x16_bf16 v[64:79], v[80:83], v[104:107], v[64:79]
    v_exp_f32 v48, v16
    v_exp_f32 v49, v17
    v_exp_f32 v50, v18
    v_mfma_f32_32x32x16_bf16 v[64:79], v[84:87], v[108:111], v[64:79]
    v_exp_f32 v51, v19
    v_exp_f32 v52, v20
    v_exp_f32 v53, v21
    v_exp_f32 v54, v22
    v_exp_f32 v55, v23
    v_exp_f32 v56, v24
    v_exp_f32 v57, v25
    v_exp_f32 v58, v26
    v_exp_f32 v59, v27
    v_exp_f32 v60, v28
    v_exp_f32 v61, v29
    v_exp_f32 v62, v30
    v_exp_f32 v63, v31
    v_pk_add_f32 v[48:49], v[48:49], 1.0 op_sel_hi:[1,0]
    v_pk_add_f32 v[50:51], v[50:51], 1.0 op_sel_hi:[1,0]
    v_pk_add_f32 v[52:53], v[52:53], 1.0 op_sel_hi:[1,0]
    v_pk_add_f32 v[54:55], v[54:55], 1.0 op_sel_hi:[1,0]
    v_pk_add_f32 v[56:57], v[56:57], 1.0 op_sel_hi:[1,0]
    v_pk_add_f32 v[58:59], v[58:59], 1.0 op_sel_hi:[1,0]
    v_pk_add_f32 v[60:61], v[60:61], 1.0 op_sel_hi:[1,0]
    v_pk_add_f32 v[62:63], v[62:63], 1.0 op_sel_hi:[1,0]
    ds_read_b64_tr_b16 v[104:105], v6 offset:18432
    ds_read_b64_tr_b16 v[106:107], v6 offset:18816
    ds_read_b64_tr_b16 v[108:109], v6 offset:19200
    ds_read_b64_tr_b16 v[110:111], v6 offset:19584
    v_rcp_f32 v48, v48
    v_rcp_f32 v49, v49
    v_rcp_f32 v50, v50
    v_rcp_f32 v51, v51
    v_rcp_f32 v52, v52
    v_rcp_f32 v53, v53
    v_rcp_f32 v54, v54
    v_rcp_f32 v55, v55
    v_rcp_f32 v56, v56
    v_rcp_f32 v57, v57
    v_rcp_f32 v58, v58
    v_rcp_f32 v59, v59
    v_rcp_f32 v60, v60
    v_rcp_f32 v61, v61
    v_rcp_f32 v62, v62
    v_rcp_f32 v63, v63
    v_pk_mul_f32 v[48:49], v[48:49], v[16:17]
    v_pk_mul_f32 v[50:51], v[50:51], v[18:19]
    v_pk_mul_f32 v[52:53], v[52:53], v[20:21]
    v_pk_mul_f32 v[54:55], v[54:55], v[22:23]
    v_pk_mul_f32 v[56:57], v[56:57], v[24:25]
    v_pk_mul_f32 v[58:59], v[58:59], v[26:27]
    v_pk_mul_f32 v[60:61], v[60:61], v[28:29]
    v_pk_mul_f32 v[62:63], v[62:63], v[30:31]
    v_cvt_pk_bf16_f32 v80, v48, v49
    v_cvt_pk_bf16_f32 v81, v50, v51
    v_cvt_pk_bf16_f32 v82, v52, v53
    v_cvt_pk_bf16_f32 v83, v54, v55
    v_cvt_pk_bf16_f32 v84, v56, v57
    v_cvt_pk_bf16_f32 v85, v58, v59
    v_cvt_pk_bf16_f32 v86, v60, v61
    v_cvt_pk_bf16_f32 v87, v62, v63
    s_waitcnt lgkmcnt(0)
    v_mfma_f32_32x32x16_bf16 v[64:79], v[80:83], v[104:107], v[64:79]
    v_mfma_f32_32x32x16_bf16 v[64:79], v[84:87], v[108:111], v[64:79]
    s_branch K2_DONE
K2_THA:
    s_waitcnt lgkmcnt(0)
    s_setprio 0
    v_mfma_f32_32x32x16_bf16 v[64:79], v[80:83], v[104:107], v[64:79]
    v_exp_f32 v48, v16
    v_exp_f32 v49, v17
    v_exp_f32 v50, v18
    v_mfma_f32_32x32x16_bf16 v[64:79], v[84:87], v[108:111], v[64:79]
    v_exp_f32 v51, v19
    v_exp_f32 v52, v20
    v_exp_f32 v53, v21
    v_exp_f32 v54, v22
    v_exp_f32 v55, v23
    v_pk_add_f32 v[48:49], v[48:49], 1.0 op_sel_hi:[1,0]
    v_pk_add_f32 v[50:51], v[50:51], 1.0 op_sel_hi:[1,0]
    v_pk_add_f32 v[52:53], v[52:53], 1.0 op_sel_hi:[1,0]
    v_pk_add_f32 v[54:55], v[54:55], 1.0 op_sel_hi:[1,0]
    ds_read_b64_tr_b16 v[104:105], v6 offset:18432
    ds_read_b64_tr_b16 v[106:107], v6 offset:18816
    v_rcp_f32 v48, v48
    v_rcp_f32 v49, v49
    v_rcp_f32 v50, v50
    v_rcp_f32 v51, v51
    v_rcp_f32 v52, v52
    v_rcp_f32 v53, v53
    v_rcp_f32 v54, v54
    v_rcp_f32 v55, v55
    v_pk_mul_f32 v[48:49], v[48:49], v[16:17]
    v_pk_mul_f32 v[50:51], v[50:51], v[18:19]
    v_pk_mul_f32 v[52:53], v[52:53], v[20:21]
    v_pk_mul_f32 v[54:55], v[54:55], v[22:23]
    v_cvt_pk_bf16_f32 v80, v48, v49
    v_cvt_pk_bf16_f32 v81, v50, v51
    v_cvt_pk_bf16_f32 v82, v52, v53
    v_cvt_pk_bf16_f32 v83, v54, v55
    s_waitcnt lgkmcnt(0)
    s_nop 0
    v_mfma_f32_32x32x16_bf16 v[64:79], v[80:83], v[104:107], v[64:79]
K2_DONE:
    s_setprio 0
    v_add_u32 v232, s53, v12
    s_cmp_eq_u32 s51, 0
    s_cbranch_scc1 K2_EPI
    s_waitcnt vmcnt(0)
    s_barrier
    v_mul_u32_u24 v5, 48, v248
    v_lshl_add_u32 v4, v13, 4, v5
    v_add_u32 v4, 32768, v4
    v_add_u32 v5, 32800, v5
    v_lshl_add_u32 v6, v13, 2, v252
    v_mul_u32_u24 v6, 48, v6
    v_bfe_u32 v88, v1, 4, 1
    v_lshl_or_b32 v88, v88, 2, v253
    v_lshl_add_u32 v6, v88, 3, v6
    v_add_u32 v6, 32768, v6
    v_and_b32 v7, 60, v1
    v_add_u32 v7, 53248, v7
    v_xor_b32 v2, v252, v13
    v_lshlrev_b32 v2, 4, v2
    v_lshl_or_b32 v2, v248, 6, v2
    v_add_u32 v2, s53, v2
    v_xor_b32 v3, 32, v2
    v_mov_b32 v80, 0
    v_mov_b32 v104, 0
    v_mov_b32 v81, 0
    v_mov_b32 v105, 0
    v_mov_b32 v82, 0
    v_mov_b32 v106, 0
    v_mov_b32 v83, 0
    v_mov_b32 v107, 0
    v_mov_b32 v84, 0
    v_mov_b32 v108, 0
    v_mov_b32 v85, 0
    v_mov_b32 v109, 0
    v_mov_b32 v86, 0
    v_mov_b32 v110, 0
    v_mov_b32 v87, 0
    v_mov_b32 v111, 0
    ds_write_b128 v250, v[80:83] offset:32768
    ds_write_b128 v250, v[80:83] offset:36864
    ds_write_b128 v250, v[80:83] offset:40960
    ds_write_b128 v250, v[80:83] offset:45056
    ds_write_b128 v250, v[80:83] offset:49152
    ds_write_b128 v250, v[80:83] offset:53248
    ds_write_b64 v251, v[80:81]
    s_waitcnt lgkmcnt(0)
    s_barrier
    s_branch K2_ROUND
K2_NOQ:
    s_waitcnt vmcnt(0)
    s_branch K2_Q1
K2_EPI:
    v_cmp_gt_u32 s[56:57], s46, v248
    v_lshlrev_b32 v230, 4, v13
    v_lshl_or_b32 v230, v248, 8, v230
    v_xor_b32 v236, 0x2000, v232
    v_xor_b32 v237, 0x4000, v232
    v_xor_b32 v238, 0x6000, v232
    s_mov_b32 s6, 0xbfb8aa3b
    s_mov_b32 s7, s6
    s_waitcnt vmcnt(10)
    v_cvt_pk_bf16_f32 v80, v64, v65
    v_cvt_pk_bf16_f32 v81, v66, v67
    v_cvt_pk_bf16_f32 v82, v68, v69
    v_cvt_pk_bf16_f32 v83, v70, v71
    ds_write_b128 v232, v[80:83]
    v_cvt_pk_bf16_f32 v84, v72, v73
    v_cvt_pk_bf16_f32 v85, v74, v75
    v_cvt_pk_bf16_f32 v86, v76, v77
    v_cvt_pk_bf16_f32 v87, v78, v79
    ds_write_b128 v232, v[84:87] offset:1024
    s_waitcnt vmcnt(0)
    v_lshlrev_b32 v128, 16, v144
    v_and_b32 v129, 0xffff0000, v144
    v_lshlrev_b32 v130, 16, v145
    v_and_b32 v131, 0xffff0000, v145
    v_lshlrev_b32 v132, 16, v146
    v_and_b32 v133, 0xffff0000, v146
    v_lshlrev_b32 v134, 16, v147
    v_and_b32 v135, 0xffff0000, v147
    v_lshlrev_b32 v136, 16, v148
    v_and_b32 v137, 0xffff0000, v148
    v_lshlrev_b32 v138, 16, v149
    v_and_b32 v139, 0xffff0000, v149
    v_lshlrev_b32 v140, 16, v150
    v_and_b32 v141, 0xffff0000, v150
    v_lshlrev_b32 v142, 16, v151
    v_and_b32 v143, 0xffff0000, v151
    s_nop 1
    v_mfma_f32_32x32x16_bf16 v[128:143], v[160:163], v[80:83], v[128:143]
    v_mfma_f32_32x32x16_bf16 v[128:143], v[164:167], v[84:87], v[128:143]
    s_waitcnt lgkmcnt(0)
    s_barrier
    ds_read_b128 v[40:43], v236 offset:0
    ds_read_b128 v[44:47], v236 offset:1024
    ds_read_b128 v[48:51], v237 offset:0
    ds_read_b128 v[52:55], v237 offset:1024
    ds_read_b128 v[56:59], v238 offset:0
    ds_read_b128 v[60:63], v238 offset:1024
    s_waitcnt lgkmcnt(5)
    v_mfma_f32_32x32x16_bf16 v[128:143], v[168:171], v[40:43], v[128:143]
    s_waitcnt lgkmcnt(4)
    v_mfma_f32_32x32x16_bf16 v[128:143], v[172:175], v[44:47], v[128:143]
    s_waitcnt lgkmcnt(3)
    v_mfma_f32_32x32x16_bf16 v[128:143], v[176:179], v[48:51], v[128:143]
    s_waitcnt lgkmcnt(2)
    v_mfma_f32_32x32x16_bf16 v[128:143], v[180:183], v[52:55], v[128:143]
    s_waitcnt lgkmcnt(1)
    v_mfma_f32_32x32x16_bf16 v[128:143], v[184:187], v[56:59], v[128:143]
    s_waitcnt lgkmcnt(0)
    v_mfma_f32_32x32x16_bf16 v[128:143], v[188:191], v[60:63], v[128:143]
    s_nop 7
    s_nop 3
    v_exp_f32 v48, v128
    v_exp_f32 v49, v129
    v_exp_f32 v50, v130
    v_exp_f32 v51, v131
    v_exp_f32 v52, v132
    v_exp_f32 v53, v133
    v_exp_f32 v54, v134
    v_exp_f32 v55, v135
    v_pk_fma_f32 v[48:49], v[48:49], s[6:7], s[6:7]
    v_pk_fma_f32 v[50:51], v[50:51], s[6:7], s[6:7]
    v_pk_fma_f32 v[52:53], v[52:53], s[6:7], s[6:7]
    v_pk_fma_f32 v[54:55], v[54:55], s[6:7], s[6:7]
    v_rcp_f32 v48, v48
    v_rcp_f32 v49, v49
    v_rcp_f32 v50, v50
    v_rcp_f32 v51, v51
    v_rcp_f32 v52, v52
    v_rcp_f32 v53, v53
    v_rcp_f32 v54, v54
    v_rcp_f32 v55, v55
    v_pk_mul_f32 v[48:49], v[48:49], v[128:129]
    v_pk_mul_f32 v[50:51], v[50:51], v[130:131]
    v_pk_mul_f32 v[52:53], v[52:53], v[132:133]
    v_pk_mul_f32 v[54:55], v[54:55], v[134:135]
    v_cvt_pk_bf16_f32 v80, v48, v49
    v_cvt_pk_bf16_f32 v81, v50, v51
    v_cvt_pk_bf16_f32 v82, v52, v53
    v_cvt_pk_bf16_f32 v83, v54, v55
    s_mov_b64 exec, s[56:57]
    buffer_store_dwordx4 v[80:83], v152, s[36:39], s5 offen offset:0 sc0 sc1
    v_exp_f32 v56, v136
    v_exp_f32 v57, v137
    v_exp_f32 v58, v138
    v_exp_f32 v59, v139
    v_exp_f32 v60, v140
    v_exp_f32 v61, v141
    v_exp_f32 v62, v142
    v_exp_f32 v63, v143
    v_pk_fma_f32 v[56:57], v[56:57], s[6:7], s[6:7]
    v_pk_fma_f32 v[58:59], v[58:59], s[6:7], s[6:7]
    v_pk_fma_f32 v[60:61], v[60:61], s[6:7], s[6:7]
    v_pk_fma_f32 v[62:63], v[62:63], s[6:7], s[6:7]
    v_rcp_f32 v56, v56
    v_rcp_f32 v57, v57
    v_rcp_f32 v58, v58
    v_rcp_f32 v59, v59
    v_rcp_f32 v60, v60
    v_rcp_f32 v61, v61
    v_rcp_f32 v62, v62
    v_rcp_f32 v63, v63
    v_pk_mul_f32 v[56:57], v[56:57], v[136:137]
    v_pk_mul_f32 v[58:59], v[58:59], v[138:139]
    v_pk_mul_f32 v[60:61], v[60:61], v[140:141]
    v_pk_mul_f32 v[62:63], v[62:63], v[142:143]
    v_cvt_pk_bf16_f32 v84, v56, v57
    v_cvt_pk_bf16_f32 v85, v58, v59
    v_cvt_pk_bf16_f32 v86, v60, v61
    v_cvt_pk_bf16_f32 v87, v62, v63
    buffer_store_dwordx4 v[84:87], v152, s[36:39], s5 offen offset:32 sc0 sc1
K2_END:
    s_endpgm
.section .rodata,"a"
.p2align 6
.amdhsa_kernel mpnn_prep_kernel
  .amdhsa_next_free_vgpr 160
  .amdhsa_next_free_sgpr 96
  .amdhsa_accum_offset 160
  .amdhsa_group_segment_fixed_size 0
  .amdhsa_kernarg_size 72
  .amdhsa_user_sgpr_count 2
  .amdhsa_user_sgpr_kernarg_segment_ptr 1
  .amdhsa_system_sgpr_workgroup_id_x 1
.end_amdhsa_kernel
.p2align 6
.amdhsa_kernel gather_scatter__mpnn_edge_mlp__graph_kernel
  .amdhsa_next_free_vgpr 256
  .amdhsa_next_free_sgpr 96
  .amdhsa_accum_offset 256
  .amdhsa_group_segment_fixed_size 0
  .amdhsa_kernarg_size 72
  .amdhsa_user_sgpr_count 2
  .amdhsa_user_sgpr_kernarg_segment_ptr 1
  .amdhsa_system_sgpr_workgroup_id_x 1
.end_amdhsa_kernel
```
